```python
import torch

def _softmax(x, axis=-1):
    return torch.softmax(x, dim=axis)
def _gelu(x):
    return torch.nn.functional.gelu(x, approximate="tanh")
def _silu(x):
    return torch.nn.functional.silu(x)
def _sigmoid(x):
    return torch.sigmoid(x)
def _layernorm(x, axis=-1, eps=1e-5):
    m = x.mean(dim=axis, keepdim=True)
    v = x.var(dim=axis, keepdim=True, unbiased=False)
    return (x - m) / torch.sqrt(v + eps)
def _scatter_add(tgt, idx, src, axis=0):
    return tgt.clone().index_add_(axis, idx, src)
def _segment_sum(src, seg, n):
    out = torch.zeros((n,) + src.shape[1:], dtype=src.dtype)
    return out.index_add_(0, seg, src)
def _pad(x, pw):
    flat = tuple(v for pair in reversed(pw) for v in pair)
    return torch.nn.functional.pad(x, flat)

kernel_name = 'standalone__kv_cache_quant_int4_int2_kv_with_per_channel_or_per_token_scales__decode'

def setup_inputs():

    _w = (lambda a: (lambda t: t.to(torch.bfloat16) if t.is_floating_point() else t)(torch.as_tensor(a)))
    B = 2
    Sq = 1
    Skv = 32768
    Hq = 32
    Hkv = 8
    Dh = 128
    bits = 3
    G = 32
    if G <= 0 or G >= Skv:
        G = max(1, Skv // 2)
    Skv = (Skv // G) * G
    ngk = Skv // G
    qmax = (1 << bits) - 1
    return {
        "q": _w((lambda *s: torch.randn(*s, dtype=torch.bfloat16) * 1.6)(B, Hq, Sq, Dh)),
        "qk": _w(torch.randint(0, qmax + 1, (B, Hkv, Skv, Dh)).to(torch.int32)),
        "qv": _w(torch.randint(0, qmax + 1, (B, Hkv, Skv, Dh)).to(torch.int32)),
        "k_scales": _w(torch.abs((lambda *s: torch.randn(*s, dtype=torch.bfloat16) * 1.6)(B, Hkv, ngk, Dh)) * 0.05 + 0.02),
        "k_zeros": _w((lambda *s: torch.randn(*s, dtype=torch.bfloat16) * 1.6)(B, Hkv, ngk, Dh) + float(qmax) / 2.0),
        "v_scales": _w(torch.abs((lambda *s: torch.randn(*s, dtype=torch.bfloat16) * 0.05)(B, Hkv, Skv, 1)) * 0.05 + 0.02),
        "v_zeros": _w((lambda *s: torch.randn(*s, dtype=torch.bfloat16) * 0.05)(B, Hkv, Skv, 1) + float(qmax) / 2.0),
    }

def reference(q, qk, qv, k_scales, k_zeros, v_scales, v_zeros):
    B, Hq, Sq, Dh = q.shape
    Hkv, Skv = qk.shape[1], qk.shape[2]
    ngk = k_scales.shape[2]
    G = Skv // ngk
    ks = (lambda x, n, axis: torch.repeat_interleave(x, n, dim=axis))(k_scales, G, axis=2)
    kz = (lambda x, n, axis: torch.repeat_interleave(x, n, dim=axis))(k_zeros, G, axis=2)
    k = ((lambda x, dt: x.to(dt))(qk, q.dtype) - kz) * ks
    v = ((lambda x, dt: x.to(dt))(qv, q.dtype) - v_zeros) * v_scales
    rep = Hq // Hkv
    if rep > 1:
        k = (lambda x, n, axis: torch.repeat_interleave(x, n, dim=axis))(k, rep, axis=1)
        v = (lambda x, n, axis: torch.repeat_interleave(x, n, dim=axis))(v, rep, axis=1)
    scale = float(Dh) ** -0.5
    logits = torch.einsum("bhqd,bhkd->bhqk", q, k) * scale
    p = _softmax(logits, axis=-1)
    o = torch.einsum("bhqk,bhkd->bhqd", p, v)
    return o
```

```asm
; @launch grid=(256,1,1) block=(256,1,1) lds=139776
.amdgcn_target "amdgcn-amd-amdhsa--gfx950"
.text
.globl standalone__kv_cache_quant_int4_int2_kv_with_per_channel_or_per_token_scales__decode_kernel
.p2align 8
.type standalone__kv_cache_quant_int4_int2_kv_with_per_channel_or_per_token_scales__decode_kernel,@function
standalone__kv_cache_quant_int4_int2_kv_with_per_channel_or_per_token_scales__decode_kernel:
    s_cmp_ge_u32 s2, 256
    s_cbranch_scc1 L_exit
    s_load_dwordx16 s[48:63], s[0:1], 0
    s_load_dwordx4 s[64:67], s[0:1], 64
    v_lshrrev_b32 v1, 6, v0
    v_and_b32 v0, 63, v0
    s_lshr_b32 s68, s2, 4
    v_readfirstlane_b32 s3, v1
    s_and_b32 s80, s2, 7
    s_lshl_b32 s80, s80, 1
    s_bfe_u32 s69, s2, 0x10003
    s_or_b32 s69, s69, s80
    s_mul_i32 s70, s68, 4
    s_mov_b32 s79, s70
    s_lshl_b32 s78, s68, 24
    s_lshr_b32 s80, s69, 1
    s_lshl_b32 s80, s80, 21
    s_add_u32 s78, s78, s80
    s_and_b32 s80, s69, 1
    s_lshl_b32 s80, s80, 15
    s_add_u32 s78, s78, s80
    s_lshl_b32 s80, s3, 13
    s_add_u32 s78, s78, s80
    s_and_b32 s80, s3, 2
    s_lshl_b32 s80, s80, 11
    s_add_u32 s78, s78, s80
    s_lshl_b32 s71, s3, 14
    s_add_u32 s71, s71, 41472
    s_lshl_b32 s81, s68, 4
    s_add_u32 s81, s81, s69
    s_lshl_b32 s74, s81, 11
    s_lshl_b32 s80, s3, 9
    s_add_u32 s74, s74, s80
    s_lshl_b32 s75, s81, 5
    s_lshl_b32 s80, s3, 3
    s_add_u32 s75, s75, s80
    s_add_u32 s75, s75, 0x80000
    v_lshlrev_b32 v14, 4, v0
    s_and_b32 s80, s3, 1
    s_lshl_b32 s86, s80, 11
    s_lshl_b32 s87, s3, 4
    s_or_b32 s80, s86, s87
    v_xor_b32 v15, s80, v14
    v_xor_b32 v192, 0, v15
    v_xor_b32 v193, 64, v15
    v_xor_b32 v194, 2064, v15
    v_xor_b32 v195, 2128, v15
    v_xor_b32 v196, 32, v15
    v_xor_b32 v197, 96, v15
    v_xor_b32 v198, 2096, v15
    v_xor_b32 v199, 2160, v15
    v_lshrrev_b32 v10, 4, v0
    v_and_b32 v9, 15, v0
    v_lshlrev_b32 v11, 4, v9
    v_lshl_add_u32 v1, v10, 9, v11
    s_and_b32 s80, s69, 1
    s_lshl_b32 s80, s80, 8
    s_or_b32 s80, s80, s86
    v_xor_b32 v1, s80, v1
    v_xor_b32 v190, 0x800, v1
    v_xor_b32 v191, 0x100, v1
    v_xor_b32 v208, 0x900, v1
    s_lshl_b32 s80, s3, 3
    s_add_u32 s81, s80, s70
    v_lshrrev_b32 v12, 3, v0
    v_add_u32 v12, s81, v12
    v_and_b32 v12, 31, v12
    v_and_b32 v13, 7, v0
    v_lshlrev_b32 v13, 4, v13
    v_lshl_add_u32 v12, v12, 8, v13
    v_and_b32 v13, 3, v0
    v_lshlrev_b32 v13, 8, v13
    v_lshl_add_u32 v13, v10, 6, v13
    s_lshl_b32 s88, s68, 16
    s_lshr_b32 s80, s69, 1
    s_lshl_b32 s80, s80, 13
    s_add_u32 s88, s88, s80
    s_and_b32 s80, s69, 1
    s_lshl_b32 s80, s80, 7
    s_add_u32 s88, s88, s80
    s_lshl_b32 s89, s68, 10
    v_lshrrev_b32 v7, 5, v0
    v_add_u32 v7, s81, v7
    v_and_b32 v8, 31, v0
    v_lshlrev_b32 v8, 4, v8
    v_add_u32 v160, 0, v7
    v_and_b32 v160, 31, v160
    v_lshl_add_u32 v160, v160, 10, v8
    v_add_u32 v161, 2, v7
    v_and_b32 v161, 31, v161
    v_lshl_add_u32 v161, v161, 10, v8
    v_add_u32 v162, 4, v7
    v_and_b32 v162, 31, v162
    v_lshl_add_u32 v162, v162, 10, v8
    v_add_u32 v163, 6, v7
    v_and_b32 v163, 31, v163
    v_lshl_add_u32 v163, v163, 10, v8
    s_waitcnt lgkmcnt(0)
    s_mov_b32 s40, s66
    s_mov_b32 s41, s67
    s_mov_b32 s42, 0x40000000
    s_mov_b32 s43, 0x20000
    v_mov_b32 v180, -1
    v_mov_b32 v181, -1
    v_lshlrev_b32 v182, 3, v0
    buffer_store_dwordx2 v[180:181], v182, s[40:43], s74 offen sc1
    s_mov_b64 exec, 1
    buffer_store_dwordx2 v[180:181], v182, s[40:43], s75 offen sc1
    s_mov_b64 exec, -1
    s_mov_b32 s32, s48
    s_mov_b32 s33, s49
    s_mov_b32 s34, 0x4000
    s_mov_b32 s35, 0x20000
    buffer_load_dwordx4 v[128:131], v13, s[32:35], s89 offen offset:0
    buffer_load_dwordx4 v[132:135], v13, s[32:35], s89 offen offset:16
    buffer_load_dwordx4 v[136:139], v13, s[32:35], s89 offen offset:32
    buffer_load_dwordx4 v[140:143], v13, s[32:35], s89 offen offset:48
    s_mov_b32 s24, s58
    s_mov_b32 s25, s59
    s_mov_b32 s26, 0x100000
    s_mov_b32 s27, 0x20000
    s_mov_b32 s28, s60
    s_mov_b32 s29, s61
    s_mov_b32 s30, 0x100000
    s_mov_b32 s31, 0x20000
    buffer_load_dwordx4 v[144:147], v12, s[24:27], s88 offen nt
    buffer_load_dwordx4 v[148:151], v12, s[28:31], s88 offen nt
    s_mov_b32 s16, s54
    s_mov_b32 s17, s55
    s_mov_b32 s18, 0x400000
    s_mov_b32 s19, 0x20000
    s_mov_b32 s20, s56
    s_mov_b32 s21, s57
    s_mov_b32 s22, 0x400000
    s_mov_b32 s23, 0x20000
    s_lshl_b32 s84, s68, 18
    s_lshr_b32 s80, s69, 1
    s_lshl_b32 s80, s80, 15
    s_add_u32 s84, s84, s80
    s_and_b32 s80, s69, 1
    s_lshl_b32 s80, s80, 9
    s_add_u32 s84, s84, s80
    s_lshl_b32 s81, s3, 12
    s_add_u32 m0, s81, 0
    s_nop 0
    buffer_load_dwordx4 v160, s[16:19], s84 offen nt lds
    s_add_u32 m0, s81, 16384
    s_nop 0
    buffer_load_dwordx4 v160, s[20:23], s84 offen nt lds
    s_add_u32 m0, s81, 1024
    s_nop 0
    buffer_load_dwordx4 v161, s[16:19], s84 offen nt lds
    s_add_u32 m0, s81, 17408
    s_nop 0
    buffer_load_dwordx4 v161, s[20:23], s84 offen nt lds
    s_add_u32 m0, s81, 2048
    s_nop 0
    buffer_load_dwordx4 v162, s[16:19], s84 offen nt lds
    s_add_u32 m0, s81, 18432
    s_nop 0
    buffer_load_dwordx4 v162, s[20:23], s84 offen nt lds
    s_add_u32 m0, s81, 3072
    s_nop 0
    buffer_load_dwordx4 v163, s[16:19], s84 offen nt lds
    s_add_u32 m0, s81, 19456
    s_nop 0
    buffer_load_dwordx4 v163, s[20:23], s84 offen nt lds
    s_mov_b32 s8, s50
    s_mov_b32 s9, s51
    s_mov_b32 s10, 0x10000000
    s_mov_b32 s11, 0x20000
    s_and_b32 s80, s79, 31
    s_lshl_b32 s80, s80, 16
    s_add_u32 s72, s80, s78
    s_xor_b32 s73, s72, 4096
    s_add_u32 s79, s79, 1
    s_add_u32 m0, s71, 0
    s_nop 0
    buffer_load_dwordx4 v192, s[8:11], s72 offen offset:0 nt lds
    buffer_load_dwordx4 v193, s[8:11], s72 offen offset:1024 nt lds
    s_add_u32 m0, s71, 2048
    s_nop 0
    buffer_load_dwordx4 v194, s[8:11], s72 offen offset:0 nt lds
    buffer_load_dwordx4 v195, s[8:11], s72 offen offset:1024 nt lds
    s_add_u32 m0, s71, 4096
    s_nop 0
    buffer_load_dwordx4 v196, s[8:11], s73 offen offset:0 nt lds
    buffer_load_dwordx4 v197, s[8:11], s73 offen offset:1024 nt lds
    s_mov_b32 s12, s52
    s_mov_b32 s13, s53
    s_mov_b32 s14, 0x10000000
    s_mov_b32 s15, 0x20000
    s_mov_b32 s36, s62
    s_mov_b32 s37, s63
    s_mov_b32 s38, 0x4000
    s_mov_b32 s39, 0x20000
    s_mov_b32 s44, s64
    s_mov_b32 s45, s65
    s_mov_b32 s46, 0x100
    s_mov_b32 s47, 0x20000
    s_and_b32 s80, s68, 1
    s_lshl_b32 s80, s80, 6
    s_and_b32 s81, s68, 14
    s_lshl_b32 s81, s81, 1
    s_add_u32 s80, s80, s81
    s_add_u32 s66, s64, s80
    s_addc_u32 s67, s65, 0
    s_mov_b32 s77, 0x3e0293ee
    s_mov_b32 s82, 0xffff0000
    s_getreg_b32 s80, hwreg(HW_REG_XCC_ID)
    s_and_b32 s80, s80, 7
    s_lshl_b32 s80, s80, 2
    s_lshr_b32 s83, 0x6060606, s80
    s_and_b32 s83, s83, 15
    s_lshl_b32 s92, s83, 3
    s_add_i32 s92, s92, 40
    s_ashr_i32 s83, s92, 6
    s_lshl_b32 s95, s80, 2
    s_add_u32 s95, s95, 128
    s_add_u32 s94, s95, s68
    s_bfe_u32 s81, s2, 0x10003
    s_or_b32 s81, s81, s3
    s_cmp_eq_u32 s81, 0
    s_cselect_b32 s94, s94, 0x1000
    s_mov_b32 s90, 0
    s_mov_b32 s88, 0x05040100
    s_mov_b32 s89, 0x07060302
    v_bfe_u32 v11, v0, 2, 2
    s_lshr_b32 s80, s3, 1
    s_lshl_b32 s80, s80, 8
    v_lshl_add_u32 v12, v10, 6, s80
    v_lshl_add_u32 v2, v11, 9, v12
    v_and_b32 v13, 3, v0
    v_lshl_add_u32 v3, v13, 9, v12
    s_lshl_b32 s80, s3, 5
    v_lshl_add_u32 v12, v10, 3, s80
    v_lshl_add_u32 v4, v11, 7, v12
    v_add_u32 v15, 36864, v12
    s_lshl_b32 s80, s3, 13
    s_add_u32 s80, s80, 107008
    v_add_u32 v14, s80, v14
    v_and_b32 v12, 3, v0
    v_bfe_u32 v7, v0, 3, 1
    v_lshl_add_u32 v7, v7, 2, v12
    v_lshlrev_b32 v7, 4, v7
    v_xor_b32 v7, s87, v7
    v_lshlrev_b32 v12, 11, v12
    v_lshl_add_u32 v12, v11, 9, v12
    v_lshl_add_u32 v12, v10, 7, v12
    v_add_u32 v12, s71, v12
    v_xor_b32 v8, 0, v7
    v_add_u32 v200, v12, v8
    v_xor_b32 v8, 16, v7
    v_add_u32 v201, v12, v8
    v_xor_b32 v8, 32, v7
    v_add_u32 v202, v12, v8
    v_xor_b32 v8, 48, v7
    v_add_u32 v203, v12, v8
    v_xor_b32 v8, 64, v7
    v_add_u32 v204, v12, v8
    v_xor_b32 v8, 80, v7
    v_add_u32 v205, v12, v8
    v_xor_b32 v8, 96, v7
    v_add_u32 v206, v12, v8
    v_xor_b32 v8, 112, v7
    v_add_u32 v207, v12, v8
    v_lshrrev_b32 v9, 1, v0
    v_lshrrev_b32 v11, 2, v0
    v_xor_b32 v11, v11, v0
    v_and_b32 v11, 1, v11
    v_and_b32 v12, 1, v9
    v_mul_u32_u24 v12, 0x404, v12
    v_lshl_or_b32 v12, v12, 16, v12
    v_xor_b32 v168, s88, v12
    v_xor_b32 v169, s89, v12
    v_lshlrev_b32 v11, 2, v11
    v_lshl_add_u32 v9, v9, 5, v11
    s_lshl_b32 s80, s3, 10
    v_add_u32 v9, s80, v9
    s_waitcnt vmcnt(14)
    v_perm_b32 v164, v146, v144, v168
    v_perm_b32 v165, v146, v144, v169
    v_perm_b32 v166, v147, v145, v168
    v_perm_b32 v167, v147, v145, v169
    ds_write_b32 v9, v164 offset:32768
    ds_write_b32 v9, v165 offset:32776
    ds_write_b32 v9, v166 offset:32784
    ds_write_b32 v9, v167 offset:32792
    v_perm_b32 v164, v150, v148, v168
    v_perm_b32 v165, v150, v148, v169
    v_perm_b32 v166, v151, v149, v168
    v_perm_b32 v167, v151, v149, v169
    ds_write_b32 v9, v164 offset:36864
    ds_write_b32 v9, v165 offset:36872
    ds_write_b32 v9, v166 offset:36880
    ds_write_b32 v9, v167 offset:36888
    s_waitcnt vmcnt(16)
    v_lshlrev_b32 v80, 16, v128
    v_and_b32 v81, s82, v128
    v_lshlrev_b32 v82, 16, v129
    v_and_b32 v83, s82, v129
    v_lshlrev_b32 v84, 16, v130
    v_and_b32 v85, s82, v130
    v_lshlrev_b32 v86, 16, v131
    v_and_b32 v87, s82, v131
    v_lshlrev_b32 v88, 16, v132
    v_and_b32 v89, s82, v132
    v_lshlrev_b32 v90, 16, v133
    v_and_b32 v91, s82, v133
    v_lshlrev_b32 v92, 16, v134
    v_and_b32 v93, s82, v134
    v_lshlrev_b32 v94, 16, v135
    v_and_b32 v95, s82, v135
    v_lshlrev_b32 v96, 16, v136
    v_and_b32 v97, s82, v136
    v_lshlrev_b32 v98, 16, v137
    v_and_b32 v99, s82, v137
    v_lshlrev_b32 v100, 16, v138
    v_and_b32 v101, s82, v138
    v_lshlrev_b32 v102, 16, v139
    v_and_b32 v103, s82, v139
    v_lshlrev_b32 v104, 16, v140
    v_and_b32 v105, s82, v140
    v_lshlrev_b32 v106, 16, v141
    v_and_b32 v107, s82, v141
    v_lshlrev_b32 v108, 16, v142
    v_and_b32 v109, s82, v142
    v_lshlrev_b32 v110, 16, v143
    v_and_b32 v111, s82, v143
    v_mov_b32 v5, 0xff7fffff
    v_mov_b32 v6, 0
    v_mov_b32 v186, 0
    v_mov_b32 v187, 0
    s_mov_b32 s76, 0
    v_and_b32 v13, 15, v0
    s_waitcnt vmcnt(4)
    s_add_u32 m0, s71, 6144
    s_nop 0
    buffer_load_dwordx4 v198, s[8:11], s73 offen offset:0 nt lds
    s_mov_b32 s91, s90
    buffer_load_ubyte v8, v13, s[44:47], s95 offen nt
    s_waitcnt vmcnt(63) lgkmcnt(0)
    s_barrier
    ds_read_b128 v[112:115], v2 offset:0
    ds_read_b128 v[116:119], v2 offset:16
    ds_read_b128 v[120:123], v2 offset:32
    ds_read_b128 v[124:127], v2 offset:48
    ds_read_b128 a[0:3], v3 offset:16384
    ds_read_b128 a[4:7], v3 offset:16400
    ds_read_b128 a[8:11], v3 offset:16416
    ds_read_b128 a[12:15], v3 offset:16432
    s_waitcnt vmcnt(5)
    buffer_load_dwordx4 v199, s[8:11], s73 offen offset:1024 nt lds
    s_waitcnt vmcnt(5)
    s_and_b32 s80, s79, 31
    s_lshl_b32 s80, s80, 16
    s_add_u32 s72, s80, s78
    s_xor_b32 s73, s72, 4096
    s_add_u32 s79, s79, 1
    s_add_u32 m0, s71, 8192
    s_nop 0
    buffer_load_dwordx4 v192, s[8:11], s72 offen offset:0 nt lds
    s_waitcnt vmcnt(5)
    buffer_load_dwordx4 v193, s[8:11], s72 offen offset:1024 nt lds
L_kloop:
    s_waitcnt vmcnt(7)
    s_cmp_gt_i32 s83, 1
    s_cbranch_scc1 L_px1
    s_waitcnt vmcnt(6)
    s_cmp_ge_i32 s83, -1
    s_cbranch_scc1 L_px1
    s_waitcnt vmcnt(4)
L_px1:
    s_add_u32 m0, s71, 10240
    s_nop 0
    buffer_load_dwordx4 v194, s[8:11], s72 offen offset:0 nt lds
    s_waitcnt lgkmcnt(0)
    v_lshlrev_b32 v11, 16, v112
    v_and_b32 v12, s82, v112
    v_mul_f32 v11, v11, v80
    v_mul_f32 v12, v12, v81
    v_cvt_pk_bf16_f32 v112, v11, v12
    v_lshlrev_b32 v11, 16, v113
    v_and_b32 v12, s82, v113
    v_mul_f32 v11, v11, v82
    v_mul_f32 v12, v12, v83
    v_cvt_pk_bf16_f32 v113, v11, v12
    v_lshlrev_b32 v11, 16, v114
    v_and_b32 v12, s82, v114
    v_mul_f32 v11, v11, v84
    v_mul_f32 v12, v12, v85
    v_cvt_pk_bf16_f32 v114, v11, v12
    v_lshlrev_b32 v11, 16, v115
    v_and_b32 v12, s82, v115
    v_mul_f32 v11, v11, v86
    v_mul_f32 v12, v12, v87
    v_cvt_pk_bf16_f32 v115, v11, v12
    s_waitcnt vmcnt(7)
    s_cmp_gt_i32 s83, 5
    s_cbranch_scc1 L_px2
    s_waitcnt vmcnt(5)
L_px2:
    buffer_load_dwordx4 v195, s[8:11], s72 offen offset:1024 nt lds
    v_lshlrev_b32 v11, 16, v116
    v_and_b32 v12, s82, v116
    v_mul_f32 v11, v11, v88
    v_mul_f32 v12, v12, v89
    v_cvt_pk_bf16_f32 v116, v11, v12
    v_lshlrev_b32 v11, 16, v117
    v_and_b32 v12, s82, v117
    v_mul_f32 v11, v11, v90
    v_mul_f32 v12, v12, v91
    v_cvt_pk_bf16_f32 v117, v11, v12
    v_lshlrev_b32 v11, 16, v118
    v_and_b32 v12, s82, v118
    v_mul_f32 v11, v11, v92
    v_mul_f32 v12, v12, v93
    v_cvt_pk_bf16_f32 v118, v11, v12
    v_lshlrev_b32 v11, 16, v119
    v_and_b32 v12, s82, v119
    v_mul_f32 v11, v11, v94
    v_mul_f32 v12, v12, v95
    v_cvt_pk_bf16_f32 v119, v11, v12
    s_waitcnt vmcnt(6)
    s_cmp_gt_i32 s83, 3
    s_cbranch_scc1 L_px3
    s_waitcnt vmcnt(4)
L_px3:
    s_add_u32 m0, s71, 12288
    s_nop 0
    buffer_load_dwordx4 v196, s[8:11], s73 offen offset:0 nt lds
    v_lshlrev_b32 v11, 16, v120
    v_and_b32 v12, s82, v120
    v_mul_f32 v11, v11, v96
    v_mul_f32 v12, v12, v97
    v_cvt_pk_bf16_f32 v120, v11, v12
    v_lshlrev_b32 v11, 16, v121
    v_and_b32 v12, s82, v121
    v_mul_f32 v11, v11, v98
    v_mul_f32 v12, v12, v99
    v_cvt_pk_bf16_f32 v121, v11, v12
    v_lshlrev_b32 v11, 16, v122
    v_and_b32 v12, s82, v122
    v_mul_f32 v11, v11, v100
    v_mul_f32 v12, v12, v101
    v_cvt_pk_bf16_f32 v122, v11, v12
    v_lshlrev_b32 v11, 16, v123
    v_and_b32 v12, s82, v123
    v_mul_f32 v11, v11, v102
    v_mul_f32 v12, v12, v103
    v_cvt_pk_bf16_f32 v123, v11, v12
    s_waitcnt vmcnt(5)
    s_cmp_gt_i32 s83, 7
    s_cbranch_scc1 L_px4
    s_waitcnt vmcnt(4)
L_px4:
    buffer_load_dwordx4 v197, s[8:11], s73 offen offset:1024 nt lds
    v_mov_b32 v7, s91
    v_cmp_eq_u32 vcc, 0, v8
    s_lshl_b32 s81, s91, 4
    s_sub_i32 s81, 7, s81
    v_cndmask_b32 v8, v8, v7, vcc
    s_nop 1
    v_add_u32_dpp v8, v8, v8 row_ror:8 row_mask:0xf bank_mask:0xf
    s_nop 1
    v_add_u32_dpp v8, v8, v8 row_ror:4 row_mask:0xf bank_mask:0xf
    s_nop 1
    v_add_u32_dpp v8, v8, v8 row_ror:2 row_mask:0xf bank_mask:0xf
    s_nop 1
    v_add_u32_dpp v8, v8, v8 row_ror:1 row_mask:0xf bank_mask:0xf
    s_nop 0
    v_readfirstlane_b32 s83, v8
    s_add_i32 s83, s83, s81
    s_mul_i32 s83, s83, 24
    s_add_i32 s83, s83, s92
    s_ashr_i32 s83, s83, 6
    v_lshlrev_b32 v11, 16, v124
    v_and_b32 v12, s82, v124
    v_mul_f32 v11, v11, v104
    v_mul_f32 v12, v12, v105
    v_cvt_pk_bf16_f32 v124, v11, v12
    v_lshlrev_b32 v11, 16, v125
    v_and_b32 v12, s82, v125
    v_mul_f32 v11, v11, v106
    v_mul_f32 v12, v12, v107
    v_cvt_pk_bf16_f32 v125, v11, v12
    v_lshlrev_b32 v11, 16, v126
    v_and_b32 v12, s82, v126
    v_mul_f32 v11, v11, v108
    v_mul_f32 v12, v12, v109
    v_cvt_pk_bf16_f32 v126, v11, v12
    v_lshlrev_b32 v11, 16, v127
    v_and_b32 v12, s82, v127
    v_mul_f32 v11, v11, v110
    v_mul_f32 v12, v12, v111
    v_cvt_pk_bf16_f32 v127, v11, v12
    ds_read_b128 v[128:131], v200 offset:0
    ds_read_b128 v[132:135], v201 offset:0
    ds_read_b128 v[136:139], v202 offset:0
    ds_read_b128 v[140:143], v203 offset:0
    ds_read_b128 v[144:147], v204 offset:0
    ds_read_b128 v[148:151], v205 offset:0
    ds_read_b128 v[152:155], v206 offset:0
    ds_read_b128 v[156:159], v207 offset:0
    v_mfma_f32_16x16x32_bf16 v[172:175], a[0:3], v[112:115], 0
    v_mfma_f32_16x16x32_bf16 v[172:175], a[4:7], v[116:119], v[172:175]
    v_mfma_f32_16x16x32_bf16 v[172:175], a[8:11], v[120:123], v[172:175]
    v_mfma_f32_16x16x32_bf16 v[172:175], a[12:15], v[124:127], v[172:175]
    s_waitcnt lgkmcnt(0)
    s_waitcnt vmcnt(5)
    s_cmp_gt_i32 s83, 0
    s_cbranch_scc1 L_px5
    s_waitcnt vmcnt(4)
    s_cmp_ge_i32 s83, 0
    s_cbranch_scc1 L_px5
    s_waitcnt vmcnt(3)
L_px5:
    s_add_u32 m0, s71, 14336
    s_nop 0
    buffer_load_dwordx4 v198, s[8:11], s73 offen offset:0 nt lds
    v_cvt_f32_i32 v128, v128
    v_cvt_f32_i32 v129, v129
    v_cvt_f32_i32 v130, v130
    v_cvt_f32_i32 v131, v131
    v_cvt_f32_i32 v132, v132
    v_cvt_f32_i32 v133, v133
    v_cvt_f32_i32 v134, v134
    v_cvt_f32_i32 v135, v135
    v_cvt_pk_bf16_f32 v160, v128, v129
    v_cvt_pk_bf16_f32 v161, v130, v131
    v_cvt_pk_bf16_f32 v162, v132, v133
    v_cvt_pk_bf16_f32 v163, v134, v135
    s_nop 1
    v_mfma_f32_16x16x32_bf16 v[168:171], v[160:163], v[112:115], 0
    s_waitcnt vmcnt(5)
    s_cmp_gt_i32 s83, 4
    s_cbranch_scc1 L_px6
    s_waitcnt vmcnt(4)
L_px6:
    buffer_load_dwordx4 v199, s[8:11], s73 offen offset:1024 nt lds
    v_cvt_f32_i32 v136, v136
    v_cvt_f32_i32 v137, v137
    v_cvt_f32_i32 v138, v138
    v_cvt_f32_i32 v139, v139
    v_cvt_f32_i32 v140, v140
    v_cvt_f32_i32 v141, v141
    v_cvt_f32_i32 v142, v142
    v_cvt_f32_i32 v143, v143
    v_cvt_pk_bf16_f32 v164, v136, v137
    v_cvt_pk_bf16_f32 v165, v138, v139
    v_cvt_pk_bf16_f32 v166, v140, v141
    v_cvt_pk_bf16_f32 v167, v142, v143
    s_nop 1
    v_mfma_f32_16x16x32_bf16 v[168:171], v[164:167], v[116:119], v[168:171]
    s_waitcnt vmcnt(5)
    s_cmp_gt_i32 s83, 2
    s_cbranch_scc1 L_px7
    s_waitcnt vmcnt(4)
L_px7:
    s_and_b32 s80, s79, 31
    s_lshl_b32 s80, s80, 16
    s_add_u32 s72, s80, s78
    s_xor_b32 s73, s72, 4096
    s_add_u32 s79, s79, 1
    s_add_u32 m0, s71, 0
    s_nop 0
    buffer_load_dwordx4 v192, s[8:11], s72 offen offset:0 nt lds
    v_cvt_f32_i32 v144, v144
    v_cvt_f32_i32 v145, v145
    v_cvt_f32_i32 v146, v146
    v_cvt_f32_i32 v147, v147
    v_cvt_f32_i32 v148, v148
    v_cvt_f32_i32 v149, v149
    v_cvt_f32_i32 v150, v150
    v_cvt_f32_i32 v151, v151
    v_cvt_pk_bf16_f32 v160, v144, v145
    v_cvt_pk_bf16_f32 v161, v146, v147
    v_cvt_pk_bf16_f32 v162, v148, v149
    v_cvt_pk_bf16_f32 v163, v150, v151
    s_nop 1
    v_mfma_f32_16x16x32_bf16 v[168:171], v[160:163], v[120:123], v[168:171]
    s_waitcnt vmcnt(5)
    s_cmp_gt_i32 s83, 6
    s_cbranch_scc1 L_px8
    s_waitcnt vmcnt(4)
L_px8:
    buffer_load_dwordx4 v193, s[8:11], s72 offen offset:1024 nt lds
    v_cvt_f32_i32 v152, v152
    v_cvt_f32_i32 v153, v153
    v_cvt_f32_i32 v154, v154
    v_cvt_f32_i32 v155, v155
    v_cvt_f32_i32 v156, v156
    v_cvt_f32_i32 v157, v157
    v_cvt_f32_i32 v158, v158
    v_cvt_f32_i32 v159, v159
    v_cvt_pk_bf16_f32 v164, v152, v153
    v_cvt_pk_bf16_f32 v165, v154, v155
    v_cvt_pk_bf16_f32 v166, v156, v157
    v_cvt_pk_bf16_f32 v167, v158, v159
    s_nop 1
    v_mfma_f32_16x16x32_bf16 v[168:171], v[164:167], v[124:127], v[168:171]
    s_waitcnt vmcnt(5)
    s_cmp_gt_i32 s83, 1
    s_cbranch_scc1 L_px9
    s_waitcnt vmcnt(4)
    s_cmp_ge_i32 s83, -1
    s_cbranch_scc1 L_px9
    s_waitcnt vmcnt(3)
L_px9:
    s_add_u32 m0, s71, 2048
    s_nop 0
    buffer_load_dwordx4 v194, s[8:11], s72 offen offset:0 nt lds
    s_nop 5
    s_mov_b32 exec_lo, 0xf000f
    s_mov_b32 exec_hi, 0xf000f
    v_sub_f32 v176, v168, v172
    v_sub_f32 v177, v169, v172
    v_sub_f32 v178, v170, v172
    v_sub_f32 v179, v171, v172
    s_mov_b64 exec, -1
    s_waitcnt vmcnt(5)
    s_cmp_gt_i32 s83, 5
    s_cbranch_scc1 L_px10
    s_waitcnt vmcnt(4)
L_px10:
    buffer_load_dwordx4 v195, s[8:11], s72 offen offset:1024 nt lds
    s_waitcnt vmcnt(5)
    s_cmp_gt_i32 s83, 3
    s_cbranch_scc1 L_px11
    s_waitcnt vmcnt(4)
L_px11:
    s_add_u32 m0, s71, 4096
    s_nop 0
    buffer_load_dwordx4 v196, s[8:11], s73 offen offset:0 nt lds
    s_waitcnt vmcnt(5)
    s_cmp_gt_i32 s83, 7
    s_cbranch_scc1 L_px12
    s_waitcnt vmcnt(4)
L_px12:
    buffer_load_dwordx4 v197, s[8:11], s73 offen offset:1024 nt lds
    s_add_u32 s90, s90, 1
    v_mov_b32 v7, s90
    s_mov_b64 exec, 1
    buffer_store_byte v7, v0, s[44:47], s94 offen
    s_mov_b64 exec, -1
    ds_read_b128 v[128:131], v200 offset:8192
    ds_read_b128 v[132:135], v201 offset:8192
    ds_read_b128 v[136:139], v202 offset:8192
    ds_read_b128 v[140:143], v203 offset:8192
    ds_read_b128 v[144:147], v204 offset:8192
    ds_read_b128 v[148:151], v205 offset:8192
    ds_read_b128 v[152:155], v206 offset:8192
    ds_read_b128 v[156:159], v207 offset:8192
    s_waitcnt lgkmcnt(0)
    s_waitcnt vmcnt(6)
    s_cmp_gt_i32 s83, 0
    s_cbranch_scc1 L_px13
    s_waitcnt vmcnt(5)
    s_cmp_ge_i32 s83, 0
    s_cbranch_scc1 L_px13
    s_waitcnt vmcnt(4)
L_px13:
    s_add_u32 m0, s71, 6144
    s_nop 0
    buffer_load_dwordx4 v198, s[8:11], s73 offen offset:0 nt lds
    s_mov_b32 s91, s90
    buffer_load_ubyte v8, v13, s[44:47], s95 offen nt
    v_cvt_f32_i32 v128, v128
    v_cvt_f32_i32 v129, v129
    v_cvt_f32_i32 v130, v130
    v_cvt_f32_i32 v131, v131
    v_cvt_f32_i32 v132, v132
    v_cvt_f32_i32 v133, v133
    v_cvt_f32_i32 v134, v134
    v_cvt_f32_i32 v135, v135
    v_cvt_pk_bf16_f32 v160, v128, v129
    v_cvt_pk_bf16_f32 v161, v130, v131
    v_cvt_pk_bf16_f32 v162, v132, v133
    v_cvt_pk_bf16_f32 v163, v134, v135
    s_nop 1
    v_mfma_f32_16x16x32_bf16 v[168:171], v[160:163], v[112:115], 0
    s_waitcnt vmcnt(7)
    s_cmp_gt_i32 s83, 4
    s_cbranch_scc1 L_px14
    s_waitcnt vmcnt(6)
L_px14:
    buffer_load_dwordx4 v199, s[8:11], s73 offen offset:1024 nt lds
    v_cvt_f32_i32 v136, v136
    v_cvt_f32_i32 v137, v137
    v_cvt_f32_i32 v138, v138
    v_cvt_f32_i32 v139, v139
    v_cvt_f32_i32 v140, v140
    v_cvt_f32_i32 v141, v141
    v_cvt_f32_i32 v142, v142
    v_cvt_f32_i32 v143, v143
    v_cvt_pk_bf16_f32 v164, v136, v137
    v_cvt_pk_bf16_f32 v165, v138, v139
    v_cvt_pk_bf16_f32 v166, v140, v141
    v_cvt_pk_bf16_f32 v167, v142, v143
    s_nop 1
    v_mfma_f32_16x16x32_bf16 v[168:171], v[164:167], v[116:119], v[168:171]
    s_waitcnt vmcnt(7)
    s_cmp_gt_i32 s83, 2
    s_cbranch_scc1 L_px15
    s_waitcnt vmcnt(6)
L_px15:
    s_and_b32 s80, s79, 31
    s_lshl_b32 s80, s80, 16
    s_add_u32 s72, s80, s78
    s_xor_b32 s73, s72, 4096
    s_add_u32 s79, s79, 1
    s_add_u32 m0, s71, 8192
    s_nop 0
    buffer_load_dwordx4 v192, s[8:11], s72 offen offset:0 nt lds
    v_cvt_f32_i32 v144, v144
    v_cvt_f32_i32 v145, v145
    v_cvt_f32_i32 v146, v146
    v_cvt_f32_i32 v147, v147
    v_cvt_f32_i32 v148, v148
    v_cvt_f32_i32 v149, v149
    v_cvt_f32_i32 v150, v150
    v_cvt_f32_i32 v151, v151
    v_cvt_pk_bf16_f32 v160, v144, v145
    v_cvt_pk_bf16_f32 v161, v146, v147
    v_cvt_pk_bf16_f32 v162, v148, v149
    v_cvt_pk_bf16_f32 v163, v150, v151
    s_nop 1
    v_mfma_f32_16x16x32_bf16 v[168:171], v[160:163], v[120:123], v[168:171]
    s_waitcnt vmcnt(7)
    s_cmp_gt_i32 s83, 6
    s_cbranch_scc1 L_px16
    s_waitcnt vmcnt(6)
L_px16:
    buffer_load_dwordx4 v193, s[8:11], s72 offen offset:1024 nt lds
    v_cvt_f32_i32 v152, v152
    v_cvt_f32_i32 v153, v153
    v_cvt_f32_i32 v154, v154
    v_cvt_f32_i32 v155, v155
    v_cvt_f32_i32 v156, v156
    v_cvt_f32_i32 v157, v157
    v_cvt_f32_i32 v158, v158
    v_cvt_f32_i32 v159, v159
    v_cvt_pk_bf16_f32 v164, v152, v153
    v_cvt_pk_bf16_f32 v165, v154, v155
    v_cvt_pk_bf16_f32 v166, v156, v157
    v_cvt_pk_bf16_f32 v167, v158, v159
    s_nop 1
    v_mfma_f32_16x16x32_bf16 v[168:171], v[164:167], v[124:127], v[168:171]
    s_waitcnt vmcnt(7)
    s_cmp_gt_i32 s83, 1
    s_cbranch_scc1 L_px17
    s_waitcnt vmcnt(6)
    s_cmp_ge_i32 s83, -1
    s_cbranch_scc1 L_px17
    s_waitcnt vmcnt(4)
L_px17:
    s_add_u32 m0, s71, 10240
    s_nop 0
    buffer_load_dwordx4 v194, s[8:11], s72 offen offset:0 nt lds
    s_nop 5
    s_mov_b32 exec_lo, 0xf000f0
    s_mov_b32 exec_hi, 0xf000f0
    v_sub_f32 v176, v168, v173
    v_sub_f32 v177, v169, v173
    v_sub_f32 v178, v170, v173
    v_sub_f32 v179, v171, v173
    s_mov_b64 exec, -1
    s_waitcnt vmcnt(7)
    s_cmp_gt_i32 s83, 5
    s_cbranch_scc1 L_px18
    s_waitcnt vmcnt(5)
L_px18:
    buffer_load_dwordx4 v195, s[8:11], s72 offen offset:1024 nt lds
    s_waitcnt vmcnt(6)
    s_cmp_gt_i32 s83, 3
    s_cbranch_scc1 L_px19
    s_waitcnt vmcnt(4)
L_px19:
    s_add_u32 m0, s71, 12288
    s_nop 0
    buffer_load_dwordx4 v196, s[8:11], s73 offen offset:0 nt lds
    s_waitcnt vmcnt(5)
    s_cmp_gt_i32 s83, 7
    s_cbranch_scc1 L_px20
    s_waitcnt vmcnt(4)
L_px20:
    buffer_load_dwordx4 v197, s[8:11], s73 offen offset:1024 nt lds
    v_mov_b32 v7, s91
    v_cmp_eq_u32 vcc, 0, v8
    s_lshl_b32 s81, s91, 4
    s_sub_i32 s81, 7, s81
    v_cndmask_b32 v8, v8, v7, vcc
    s_nop 1
    v_add_u32_dpp v8, v8, v8 row_ror:8 row_mask:0xf bank_mask:0xf
    s_nop 1
    v_add_u32_dpp v8, v8, v8 row_ror:4 row_mask:0xf bank_mask:0xf
    s_nop 1
    v_add_u32_dpp v8, v8, v8 row_ror:2 row_mask:0xf bank_mask:0xf
    s_nop 1
    v_add_u32_dpp v8, v8, v8 row_ror:1 row_mask:0xf bank_mask:0xf
    s_nop 0
    v_readfirstlane_b32 s83, v8
    s_add_i32 s83, s83, s81
    s_mul_i32 s83, s83, 24
    s_add_i32 s83, s83, s92
    s_ashr_i32 s83, s83, 6
    ds_read_b128 v[128:131], v200 offset:0
    ds_read_b128 v[132:135], v201 offset:0
    ds_read_b128 v[136:139], v202 offset:0
    ds_read_b128 v[140:143], v203 offset:0
    ds_read_b128 v[144:147], v204 offset:0
    ds_read_b128 v[148:151], v205 offset:0
    ds_read_b128 v[152:155], v206 offset:0
    ds_read_b128 v[156:159], v207 offset:0
    s_waitcnt lgkmcnt(0)
    s_waitcnt vmcnt(5)
    s_cmp_gt_i32 s83, 0
    s_cbranch_scc1 L_px21
    s_waitcnt vmcnt(4)
    s_cmp_ge_i32 s83, 0
    s_cbranch_scc1 L_px21
    s_waitcnt vmcnt(3)
L_px21:
    s_add_u32 m0, s71, 14336
    s_nop 0
    buffer_load_dwordx4 v198, s[8:11], s73 offen offset:0 nt lds
    v_cvt_f32_i32 v128, v128
    v_cvt_f32_i32 v129, v129
    v_cvt_f32_i32 v130, v130
    v_cvt_f32_i32 v131, v131
    v_cvt_f32_i32 v132, v132
    v_cvt_f32_i32 v133, v133
    v_cvt_f32_i32 v134, v134
    v_cvt_f32_i32 v135, v135
    v_cvt_pk_bf16_f32 v160, v128, v129
    v_cvt_pk_bf16_f32 v161, v130, v131
    v_cvt_pk_bf16_f32 v162, v132, v133
    v_cvt_pk_bf16_f32 v163, v134, v135
    s_nop 1
    v_mfma_f32_16x16x32_bf16 v[168:171], v[160:163], v[112:115], 0
    s_waitcnt vmcnt(5)
    s_cmp_gt_i32 s83, 4
    s_cbranch_scc1 L_px22
    s_waitcnt vmcnt(4)
L_px22:
    buffer_load_dwordx4 v199, s[8:11], s73 offen offset:1024 nt lds
    v_cvt_f32_i32 v136, v136
    v_cvt_f32_i32 v137, v137
    v_cvt_f32_i32 v138, v138
    v_cvt_f32_i32 v139, v139
    v_cvt_f32_i32 v140, v140
    v_cvt_f32_i32 v141, v141
    v_cvt_f32_i32 v142, v142
    v_cvt_f32_i32 v143, v143
    v_cvt_pk_bf16_f32 v164, v136, v137
    v_cvt_pk_bf16_f32 v165, v138, v139
    v_cvt_pk_bf16_f32 v166, v140, v141
    v_cvt_pk_bf16_f32 v167, v142, v143
    s_nop 1
    v_mfma_f32_16x16x32_bf16 v[168:171], v[164:167], v[116:119], v[168:171]
    s_waitcnt vmcnt(5)
    s_cmp_gt_i32 s83, 2
    s_cbranch_scc1 L_px23
    s_waitcnt vmcnt(4)
L_px23:
    s_and_b32 s80, s79, 31
    s_lshl_b32 s80, s80, 16
    s_add_u32 s72, s80, s78
    s_xor_b32 s73, s72, 4096
    s_add_u32 s79, s79, 1
    s_add_u32 m0, s71, 0
    s_nop 0
    buffer_load_dwordx4 v192, s[8:11], s72 offen offset:0 nt lds
    v_cvt_f32_i32 v144, v144
    v_cvt_f32_i32 v145, v145
    v_cvt_f32_i32 v146, v146
    v_cvt_f32_i32 v147, v147
    v_cvt_f32_i32 v148, v148
    v_cvt_f32_i32 v149, v149
    v_cvt_f32_i32 v150, v150
    v_cvt_f32_i32 v151, v151
    v_cvt_pk_bf16_f32 v160, v144, v145
    v_cvt_pk_bf16_f32 v161, v146, v147
    v_cvt_pk_bf16_f32 v162, v148, v149
    v_cvt_pk_bf16_f32 v163, v150, v151
    s_nop 1
    v_mfma_f32_16x16x32_bf16 v[168:171], v[160:163], v[120:123], v[168:171]
    s_waitcnt vmcnt(5)
    s_cmp_gt_i32 s83, 6
    s_cbranch_scc1 L_px24
    s_waitcnt vmcnt(4)
L_px24:
    buffer_load_dwordx4 v193, s[8:11], s72 offen offset:1024 nt lds
    v_cvt_f32_i32 v152, v152
    v_cvt_f32_i32 v153, v153
    v_cvt_f32_i32 v154, v154
    v_cvt_f32_i32 v155, v155
    v_cvt_f32_i32 v156, v156
    v_cvt_f32_i32 v157, v157
    v_cvt_f32_i32 v158, v158
    v_cvt_f32_i32 v159, v159
    v_cvt_pk_bf16_f32 v164, v152, v153
    v_cvt_pk_bf16_f32 v165, v154, v155
    v_cvt_pk_bf16_f32 v166, v156, v157
    v_cvt_pk_bf16_f32 v167, v158, v159
    s_nop 1
    v_mfma_f32_16x16x32_bf16 v[168:171], v[164:167], v[124:127], v[168:171]
    s_waitcnt vmcnt(5)
    s_cmp_gt_i32 s83, 1
    s_cbranch_scc1 L_px25
    s_waitcnt vmcnt(4)
    s_cmp_ge_i32 s83, -1
    s_cbranch_scc1 L_px25
    s_waitcnt vmcnt(3)
L_px25:
    s_add_u32 m0, s71, 2048
    s_nop 0
    buffer_load_dwordx4 v194, s[8:11], s72 offen offset:0 nt lds
    s_nop 5
    s_mov_b32 exec_lo, 0xf000f00
    s_mov_b32 exec_hi, 0xf000f00
    v_sub_f32 v176, v168, v174
    v_sub_f32 v177, v169, v174
    v_sub_f32 v178, v170, v174
    v_sub_f32 v179, v171, v174
    s_mov_b64 exec, -1
    s_waitcnt vmcnt(5)
    s_cmp_gt_i32 s83, 5
    s_cbranch_scc1 L_px26
    s_waitcnt vmcnt(4)
L_px26:
    buffer_load_dwordx4 v195, s[8:11], s72 offen offset:1024 nt lds
    s_waitcnt vmcnt(5)
    s_cmp_gt_i32 s83, 3
    s_cbranch_scc1 L_px27
    s_waitcnt vmcnt(4)
L_px27:
    s_add_u32 m0, s71, 4096
    s_nop 0
    buffer_load_dwordx4 v196, s[8:11], s73 offen offset:0 nt lds
    s_waitcnt vmcnt(5)
    s_cmp_gt_i32 s83, 7
    s_cbranch_scc1 L_px28
    s_waitcnt vmcnt(4)
L_px28:
    buffer_load_dwordx4 v197, s[8:11], s73 offen offset:1024 nt lds
    s_add_u32 s90, s90, 1
    v_mov_b32 v7, s90
    s_mov_b64 exec, 1
    buffer_store_byte v7, v0, s[44:47], s94 offen
    s_mov_b64 exec, -1
    ds_read_b128 v[128:131], v200 offset:8192
    ds_read_b128 v[132:135], v201 offset:8192
    ds_read_b128 v[136:139], v202 offset:8192
    ds_read_b128 v[140:143], v203 offset:8192
    ds_read_b128 v[144:147], v204 offset:8192
    ds_read_b128 v[148:151], v205 offset:8192
    ds_read_b128 v[152:155], v206 offset:8192
    ds_read_b128 v[156:159], v207 offset:8192
    s_waitcnt lgkmcnt(0)
    s_waitcnt vmcnt(6)
    s_cmp_gt_i32 s83, 0
    s_cbranch_scc1 L_px29
    s_waitcnt vmcnt(5)
    s_cmp_ge_i32 s83, 0
    s_cbranch_scc1 L_px29
    s_waitcnt vmcnt(4)
L_px29:
    s_add_u32 m0, s71, 6144
    s_nop 0
    buffer_load_dwordx4 v198, s[8:11], s73 offen offset:0 nt lds
    s_mov_b32 s91, s90
    buffer_load_ubyte v8, v13, s[44:47], s95 offen nt
    v_cvt_f32_i32 v128, v128
    v_cvt_f32_i32 v129, v129
    v_cvt_f32_i32 v130, v130
    v_cvt_f32_i32 v131, v131
    v_cvt_f32_i32 v132, v132
    v_cvt_f32_i32 v133, v133
    v_cvt_f32_i32 v134, v134
    v_cvt_f32_i32 v135, v135
    v_cvt_pk_bf16_f32 v160, v128, v129
    v_cvt_pk_bf16_f32 v161, v130, v131
    v_cvt_pk_bf16_f32 v162, v132, v133
    v_cvt_pk_bf16_f32 v163, v134, v135
    s_nop 1
    v_mfma_f32_16x16x32_bf16 v[168:171], v[160:163], v[112:115], 0
    s_waitcnt vmcnt(7)
    s_cmp_gt_i32 s83, 4
    s_cbranch_scc1 L_px30
    s_waitcnt vmcnt(6)
L_px30:
    buffer_load_dwordx4 v199, s[8:11], s73 offen offset:1024 nt lds
    v_cvt_f32_i32 v136, v136
    v_cvt_f32_i32 v137, v137
    v_cvt_f32_i32 v138, v138
    v_cvt_f32_i32 v139, v139
    v_cvt_f32_i32 v140, v140
    v_cvt_f32_i32 v141, v141
    v_cvt_f32_i32 v142, v142
    v_cvt_f32_i32 v143, v143
    v_cvt_pk_bf16_f32 v164, v136, v137
    v_cvt_pk_bf16_f32 v165, v138, v139
    v_cvt_pk_bf16_f32 v166, v140, v141
    v_cvt_pk_bf16_f32 v167, v142, v143
    s_nop 1
    v_mfma_f32_16x16x32_bf16 v[168:171], v[164:167], v[116:119], v[168:171]
    s_waitcnt vmcnt(7)
    s_cmp_gt_i32 s83, 2
    s_cbranch_scc1 L_px31
    s_waitcnt vmcnt(6)
L_px31:
    s_and_b32 s80, s79, 31
    s_lshl_b32 s80, s80, 16
    s_add_u32 s72, s80, s78
    s_xor_b32 s73, s72, 4096
    s_add_u32 s79, s79, 1
    s_add_u32 m0, s71, 8192
    s_nop 0
    buffer_load_dwordx4 v192, s[8:11], s72 offen offset:0 nt lds
    v_cvt_f32_i32 v144, v144
    v_cvt_f32_i32 v145, v145
    v_cvt_f32_i32 v146, v146
    v_cvt_f32_i32 v147, v147
    v_cvt_f32_i32 v148, v148
    v_cvt_f32_i32 v149, v149
    v_cvt_f32_i32 v150, v150
    v_cvt_f32_i32 v151, v151
    v_cvt_pk_bf16_f32 v160, v144, v145
    v_cvt_pk_bf16_f32 v161, v146, v147
    v_cvt_pk_bf16_f32 v162, v148, v149
    v_cvt_pk_bf16_f32 v163, v150, v151
    s_nop 1
    v_mfma_f32_16x16x32_bf16 v[168:171], v[160:163], v[120:123], v[168:171]
    s_waitcnt vmcnt(7)
    s_cmp_gt_i32 s83, 6
    s_cbranch_scc1 L_px32
    s_waitcnt vmcnt(6)
L_px32:
    buffer_load_dwordx4 v193, s[8:11], s72 offen offset:1024 nt lds
    v_cvt_f32_i32 v152, v152
    v_cvt_f32_i32 v153, v153
    v_cvt_f32_i32 v154, v154
    v_cvt_f32_i32 v155, v155
    v_cvt_f32_i32 v156, v156
    v_cvt_f32_i32 v157, v157
    v_cvt_f32_i32 v158, v158
    v_cvt_f32_i32 v159, v159
    v_cvt_pk_bf16_f32 v164, v152, v153
    v_cvt_pk_bf16_f32 v165, v154, v155
    v_cvt_pk_bf16_f32 v166, v156, v157
    v_cvt_pk_bf16_f32 v167, v158, v159
    s_nop 1
    v_mfma_f32_16x16x32_bf16 v[168:171], v[164:167], v[124:127], v[168:171]
    v_add_u32 v2, 2048, v2
    v_add_u32 v3, 2048, v3
    s_nop 3
    s_mov_b32 exec_lo, 0xf000f000
    s_mov_b32 exec_hi, 0xf000f000
    v_sub_f32 v176, v168, v175
    v_sub_f32 v177, v169, v175
    v_sub_f32 v178, v170, v175
    v_sub_f32 v179, v171, v175
    s_mov_b64 exec, -1
    ds_read_b128 v[112:115], v2 offset:0
    ds_read_b128 v[116:119], v2 offset:16
    ds_read_b128 v[120:123], v2 offset:32
    ds_read_b128 v[124:127], v2 offset:48
    ds_read_b128 a[0:3], v3 offset:16384
    ds_read_b128 a[4:7], v3 offset:16400
    ds_read_b128 a[8:11], v3 offset:16416
    ds_read_b128 a[12:15], v3 offset:16432
    ds_write_b128 v14, v[176:179]
    v_max3_f32 v5, v5, v176, v177
    v_max3_f32 v5, v5, v178, v179
    v_add_u32 v14, 1024, v14
    s_add_u32 s76, s76, 1
    s_cmp_lt_u32 s76, 7
    s_cbranch_scc1 L_kloop
    s_waitcnt vmcnt(7)
    s_cmp_gt_i32 s83, 1
    s_cbranch_scc1 L_px33
    s_waitcnt vmcnt(6)
    s_cmp_ge_i32 s83, -1
    s_cbranch_scc1 L_px33
    s_waitcnt vmcnt(4)
L_px33:
    s_add_u32 m0, s71, 10240
    s_nop 0
    buffer_load_dwordx4 v194, s[8:11], s72 offen offset:0 nt lds
    s_waitcnt lgkmcnt(0)
    v_lshlrev_b32 v11, 16, v112
    v_and_b32 v12, s82, v112
    v_mul_f32 v11, v11, v80
    v_mul_f32 v12, v12, v81
    v_cvt_pk_bf16_f32 v112, v11, v12
    v_lshlrev_b32 v11, 16, v113
    v_and_b32 v12, s82, v113
    v_mul_f32 v11, v11, v82
    v_mul_f32 v12, v12, v83
    v_cvt_pk_bf16_f32 v113, v11, v12
    v_lshlrev_b32 v11, 16, v114
    v_and_b32 v12, s82, v114
    v_mul_f32 v11, v11, v84
    v_mul_f32 v12, v12, v85
    v_cvt_pk_bf16_f32 v114, v11, v12
    v_lshlrev_b32 v11, 16, v115
    v_and_b32 v12, s82, v115
    v_mul_f32 v11, v11, v86
    v_mul_f32 v12, v12, v87
    v_cvt_pk_bf16_f32 v115, v11, v12
    s_waitcnt vmcnt(7)
    s_cmp_gt_i32 s83, 5
    s_cbranch_scc1 L_px34
    s_waitcnt vmcnt(5)
L_px34:
    buffer_load_dwordx4 v195, s[8:11], s72 offen offset:1024 nt lds
    v_lshlrev_b32 v11, 16, v116
    v_and_b32 v12, s82, v116
    v_mul_f32 v11, v11, v88
    v_mul_f32 v12, v12, v89
    v_cvt_pk_bf16_f32 v116, v11, v12
    v_lshlrev_b32 v11, 16, v117
    v_and_b32 v12, s82, v117
    v_mul_f32 v11, v11, v90
    v_mul_f32 v12, v12, v91
    v_cvt_pk_bf16_f32 v117, v11, v12
    v_lshlrev_b32 v11, 16, v118
    v_and_b32 v12, s82, v118
    v_mul_f32 v11, v11, v92
    v_mul_f32 v12, v12, v93
    v_cvt_pk_bf16_f32 v118, v11, v12
    v_lshlrev_b32 v11, 16, v119
    v_and_b32 v12, s82, v119
    v_mul_f32 v11, v11, v94
    v_mul_f32 v12, v12, v95
    v_cvt_pk_bf16_f32 v119, v11, v12
    s_waitcnt vmcnt(6)
    s_cmp_gt_i32 s83, 3
    s_cbranch_scc1 L_px35
    s_waitcnt vmcnt(4)
L_px35:
    s_add_u32 m0, s71, 12288
    s_nop 0
    buffer_load_dwordx4 v196, s[8:11], s73 offen offset:0 nt lds
    v_lshlrev_b32 v11, 16, v120
    v_and_b32 v12, s82, v120
    v_mul_f32 v11, v11, v96
    v_mul_f32 v12, v12, v97
    v_cvt_pk_bf16_f32 v120, v11, v12
    v_lshlrev_b32 v11, 16, v121
    v_and_b32 v12, s82, v121
    v_mul_f32 v11, v11, v98
    v_mul_f32 v12, v12, v99
    v_cvt_pk_bf16_f32 v121, v11, v12
    v_lshlrev_b32 v11, 16, v122
    v_and_b32 v12, s82, v122
    v_mul_f32 v11, v11, v100
    v_mul_f32 v12, v12, v101
    v_cvt_pk_bf16_f32 v122, v11, v12
    v_lshlrev_b32 v11, 16, v123
    v_and_b32 v12, s82, v123
    v_mul_f32 v11, v11, v102
    v_mul_f32 v12, v12, v103
    v_cvt_pk_bf16_f32 v123, v11, v12
    s_waitcnt vmcnt(5)
    s_cmp_gt_i32 s83, 7
    s_cbranch_scc1 L_px36
    s_waitcnt vmcnt(4)
L_px36:
    buffer_load_dwordx4 v197, s[8:11], s73 offen offset:1024 nt lds
    v_mov_b32 v7, s91
    v_cmp_eq_u32 vcc, 0, v8
    s_lshl_b32 s81, s91, 4
    s_sub_i32 s81, 7, s81
    v_cndmask_b32 v8, v8, v7, vcc
    s_nop 1
    v_add_u32_dpp v8, v8, v8 row_ror:8 row_mask:0xf bank_mask:0xf
    s_nop 1
    v_add_u32_dpp v8, v8, v8 row_ror:4 row_mask:0xf bank_mask:0xf
    s_nop 1
    v_add_u32_dpp v8, v8, v8 row_ror:2 row_mask:0xf bank_mask:0xf
    s_nop 1
    v_add_u32_dpp v8, v8, v8 row_ror:1 row_mask:0xf bank_mask:0xf
    s_nop 0
    v_readfirstlane_b32 s83, v8
    s_add_i32 s83, s83, s81
    s_mul_i32 s83, s83, 24
    s_add_i32 s83, s83, s92
    s_ashr_i32 s83, s83, 6
    v_lshlrev_b32 v11, 16, v124
    v_and_b32 v12, s82, v124
    v_mul_f32 v11, v11, v104
    v_mul_f32 v12, v12, v105
    v_cvt_pk_bf16_f32 v124, v11, v12
    v_lshlrev_b32 v11, 16, v125
    v_and_b32 v12, s82, v125
    v_mul_f32 v11, v11, v106
    v_mul_f32 v12, v12, v107
    v_cvt_pk_bf16_f32 v125, v11, v12
    v_lshlrev_b32 v11, 16, v126
    v_and_b32 v12, s82, v126
    v_mul_f32 v11, v11, v108
    v_mul_f32 v12, v12, v109
    v_cvt_pk_bf16_f32 v126, v11, v12
    v_lshlrev_b32 v11, 16, v127
    v_and_b32 v12, s82, v127
    v_mul_f32 v11, v11, v110
    v_mul_f32 v12, v12, v111
    v_cvt_pk_bf16_f32 v127, v11, v12
    ds_read_b128 v[128:131], v200 offset:0
    ds_read_b128 v[132:135], v201 offset:0
    ds_read_b128 v[136:139], v202 offset:0
    ds_read_b128 v[140:143], v203 offset:0
    ds_read_b128 v[144:147], v204 offset:0
    ds_read_b128 v[148:151], v205 offset:0
    ds_read_b128 v[152:155], v206 offset:0
    ds_read_b128 v[156:159], v207 offset:0
    v_mfma_f32_16x16x32_bf16 v[172:175], a[0:3], v[112:115], 0
    v_mfma_f32_16x16x32_bf16 v[172:175], a[4:7], v[116:119], v[172:175]
    v_mfma_f32_16x16x32_bf16 v[172:175], a[8:11], v[120:123], v[172:175]
    v_mfma_f32_16x16x32_bf16 v[172:175], a[12:15], v[124:127], v[172:175]
    s_waitcnt lgkmcnt(0)
    s_waitcnt vmcnt(5)
    s_cmp_gt_i32 s83, 0
    s_cbranch_scc1 L_px37
    s_waitcnt vmcnt(4)
    s_cmp_ge_i32 s83, 0
    s_cbranch_scc1 L_px37
    s_waitcnt vmcnt(3)
L_px37:
    s_add_u32 m0, s71, 14336
    s_nop 0
    buffer_load_dwordx4 v198, s[8:11], s73 offen offset:0 nt lds
    v_cvt_f32_i32 v128, v128
    v_cvt_f32_i32 v129, v129
    v_cvt_f32_i32 v130, v130
    v_cvt_f32_i32 v131, v131
    v_cvt_f32_i32 v132, v132
    v_cvt_f32_i32 v133, v133
    v_cvt_f32_i32 v134, v134
    v_cvt_f32_i32 v135, v135
    v_cvt_pk_bf16_f32 v160, v128, v129
    v_cvt_pk_bf16_f32 v161, v130, v131
    v_cvt_pk_bf16_f32 v162, v132, v133
    v_cvt_pk_bf16_f32 v163, v134, v135
    s_nop 1
    v_mfma_f32_16x16x32_bf16 v[168:171], v[160:163], v[112:115], 0
    s_waitcnt vmcnt(5)
    s_cmp_gt_i32 s83, 4
    s_cbranch_scc1 L_px38
    s_waitcnt vmcnt(4)
L_px38:
    buffer_load_dwordx4 v199, s[8:11], s73 offen offset:1024 nt lds
    v_cvt_f32_i32 v136, v136
    v_cvt_f32_i32 v137, v137
    v_cvt_f32_i32 v138, v138
    v_cvt_f32_i32 v139, v139
    v_cvt_f32_i32 v140, v140
    v_cvt_f32_i32 v141, v141
    v_cvt_f32_i32 v142, v142
    v_cvt_f32_i32 v143, v143
    v_cvt_pk_bf16_f32 v164, v136, v137
    v_cvt_pk_bf16_f32 v165, v138, v139
    v_cvt_pk_bf16_f32 v166, v140, v141
    v_cvt_pk_bf16_f32 v167, v142, v143
    s_nop 1
    v_mfma_f32_16x16x32_bf16 v[168:171], v[164:167], v[116:119], v[168:171]
    s_waitcnt vmcnt(5)
    s_cmp_gt_i32 s83, 2
    s_cbranch_scc1 L_px39
    s_waitcnt vmcnt(4)
L_px39:
    s_and_b32 s80, s79, 31
    s_lshl_b32 s80, s80, 16
    s_add_u32 s72, s80, s78
    s_xor_b32 s73, s72, 4096
    s_add_u32 s79, s79, 1
    s_add_u32 m0, s71, 0
    s_nop 0
    buffer_load_dwordx4 v192, s[8:11], s72 offen offset:0 nt lds
    v_cvt_f32_i32 v144, v144
    v_cvt_f32_i32 v145, v145
    v_cvt_f32_i32 v146, v146
    v_cvt_f32_i32 v147, v147
    v_cvt_f32_i32 v148, v148
    v_cvt_f32_i32 v149, v149
    v_cvt_f32_i32 v150, v150
    v_cvt_f32_i32 v151, v151
    v_cvt_pk_bf16_f32 v160, v144, v145
    v_cvt_pk_bf16_f32 v161, v146, v147
    v_cvt_pk_bf16_f32 v162, v148, v149
    v_cvt_pk_bf16_f32 v163, v150, v151
    s_nop 1
    v_mfma_f32_16x16x32_bf16 v[168:171], v[160:163], v[120:123], v[168:171]
    s_waitcnt vmcnt(5)
    s_cmp_gt_i32 s83, 6
    s_cbranch_scc1 L_px40
    s_waitcnt vmcnt(4)
L_px40:
    buffer_load_dwordx4 v193, s[8:11], s72 offen offset:1024 nt lds
    v_cvt_f32_i32 v152, v152
    v_cvt_f32_i32 v153, v153
    v_cvt_f32_i32 v154, v154
    v_cvt_f32_i32 v155, v155
    v_cvt_f32_i32 v156, v156
    v_cvt_f32_i32 v157, v157
    v_cvt_f32_i32 v158, v158
    v_cvt_f32_i32 v159, v159
    v_cvt_pk_bf16_f32 v164, v152, v153
    v_cvt_pk_bf16_f32 v165, v154, v155
    v_cvt_pk_bf16_f32 v166, v156, v157
    v_cvt_pk_bf16_f32 v167, v158, v159
    s_nop 1
    v_mfma_f32_16x16x32_bf16 v[168:171], v[164:167], v[124:127], v[168:171]
    s_waitcnt vmcnt(5)
    s_cmp_gt_i32 s83, 1
    s_cbranch_scc1 L_px41
    s_waitcnt vmcnt(4)
    s_cmp_ge_i32 s83, -1
    s_cbranch_scc1 L_px41
    s_waitcnt vmcnt(3)
L_px41:
    s_add_u32 m0, s71, 2048
    s_nop 0
    buffer_load_dwordx4 v194, s[8:11], s72 offen offset:0 nt lds
    s_nop 5
    s_mov_b32 exec_lo, 0xf000f
    s_mov_b32 exec_hi, 0xf000f
    v_sub_f32 v176, v168, v172
    v_sub_f32 v177, v169, v172
    v_sub_f32 v178, v170, v172
    v_sub_f32 v179, v171, v172
    s_mov_b64 exec, -1
    s_waitcnt vmcnt(5)
    s_cmp_gt_i32 s83, 5
    s_cbranch_scc1 L_px42
    s_waitcnt vmcnt(4)
L_px42:
    buffer_load_dwordx4 v195, s[8:11], s72 offen offset:1024 nt lds
    s_waitcnt vmcnt(5)
    s_cmp_gt_i32 s83, 3
    s_cbranch_scc1 L_px43
    s_waitcnt vmcnt(4)
L_px43:
    s_add_u32 m0, s71, 4096
    s_nop 0
    buffer_load_dwordx4 v196, s[8:11], s73 offen offset:0 nt lds
    s_waitcnt vmcnt(5)
    s_cmp_gt_i32 s83, 7
    s_cbranch_scc1 L_px44
    s_waitcnt vmcnt(4)
L_px44:
    buffer_load_dwordx4 v197, s[8:11], s73 offen offset:1024 nt lds
    s_add_u32 s90, s90, 1
    v_mov_b32 v7, s90
    s_mov_b64 exec, 1
    buffer_store_byte v7, v0, s[44:47], s94 offen
    s_mov_b64 exec, -1
    ds_read_b128 v[128:131], v200 offset:8192
    ds_read_b128 v[132:135], v201 offset:8192
    ds_read_b128 v[136:139], v202 offset:8192
    ds_read_b128 v[140:143], v203 offset:8192
    ds_read_b128 v[144:147], v204 offset:8192
    ds_read_b128 v[148:151], v205 offset:8192
    ds_read_b128 v[152:155], v206 offset:8192
    ds_read_b128 v[156:159], v207 offset:8192
    s_waitcnt lgkmcnt(0)
    s_waitcnt vmcnt(6)
    s_cmp_gt_i32 s83, 0
    s_cbranch_scc1 L_px45
    s_waitcnt vmcnt(5)
    s_cmp_ge_i32 s83, 0
    s_cbranch_scc1 L_px45
    s_waitcnt vmcnt(4)
L_px45:
    s_add_u32 m0, s71, 6144
    s_nop 0
    buffer_load_dwordx4 v198, s[8:11], s73 offen offset:0 nt lds
    s_mov_b32 s91, s90
    buffer_load_ubyte v8, v13, s[44:47], s95 offen nt
    v_cvt_f32_i32 v128, v128
    v_cvt_f32_i32 v129, v129
    v_cvt_f32_i32 v130, v130
    v_cvt_f32_i32 v131, v131
    v_cvt_f32_i32 v132, v132
    v_cvt_f32_i32 v133, v133
    v_cvt_f32_i32 v134, v134
    v_cvt_f32_i32 v135, v135
    v_cvt_pk_bf16_f32 v160, v128, v129
    v_cvt_pk_bf16_f32 v161, v130, v131
    v_cvt_pk_bf16_f32 v162, v132, v133
    v_cvt_pk_bf16_f32 v163, v134, v135
    s_nop 1
    v_mfma_f32_16x16x32_bf16 v[168:171], v[160:163], v[112:115], 0
    s_waitcnt vmcnt(7)
    s_cmp_gt_i32 s83, 4
    s_cbranch_scc1 L_px46
    s_waitcnt vmcnt(6)
L_px46:
    buffer_load_dwordx4 v199, s[8:11], s73 offen offset:1024 nt lds
    v_cvt_f32_i32 v136, v136
    v_cvt_f32_i32 v137, v137
    v_cvt_f32_i32 v138, v138
    v_cvt_f32_i32 v139, v139
    v_cvt_f32_i32 v140, v140
    v_cvt_f32_i32 v141, v141
    v_cvt_f32_i32 v142, v142
    v_cvt_f32_i32 v143, v143
    v_cvt_pk_bf16_f32 v164, v136, v137
    v_cvt_pk_bf16_f32 v165, v138, v139
    v_cvt_pk_bf16_f32 v166, v140, v141
    v_cvt_pk_bf16_f32 v167, v142, v143
    s_nop 1
    v_mfma_f32_16x16x32_bf16 v[168:171], v[164:167], v[116:119], v[168:171]
    s_waitcnt vmcnt(7)
    s_cmp_gt_i32 s83, 2
    s_cbranch_scc1 L_px47
    s_waitcnt vmcnt(6)
L_px47:
    s_and_b32 s80, s79, 31
    s_lshl_b32 s80, s80, 16
    s_add_u32 s72, s80, s78
    s_xor_b32 s73, s72, 4096
    s_add_u32 s79, s79, 1
    s_add_u32 m0, s71, 8192
    s_nop 0
    buffer_load_dwordx4 v192, s[8:11], s72 offen offset:0 nt lds
    v_cvt_f32_i32 v144, v144
    v_cvt_f32_i32 v145, v145
    v_cvt_f32_i32 v146, v146
    v_cvt_f32_i32 v147, v147
    v_cvt_f32_i32 v148, v148
    v_cvt_f32_i32 v149, v149
    v_cvt_f32_i32 v150, v150
    v_cvt_f32_i32 v151, v151
    v_cvt_pk_bf16_f32 v160, v144, v145
    v_cvt_pk_bf16_f32 v161, v146, v147
    v_cvt_pk_bf16_f32 v162, v148, v149
    v_cvt_pk_bf16_f32 v163, v150, v151
    s_nop 1
    v_mfma_f32_16x16x32_bf16 v[168:171], v[160:163], v[120:123], v[168:171]
    s_waitcnt vmcnt(7)
    s_cmp_gt_i32 s83, 6
    s_cbranch_scc1 L_px48
    s_waitcnt vmcnt(6)
L_px48:
    buffer_load_dwordx4 v193, s[8:11], s72 offen offset:1024 nt lds
    v_cvt_f32_i32 v152, v152
    v_cvt_f32_i32 v153, v153
    v_cvt_f32_i32 v154, v154
    v_cvt_f32_i32 v155, v155
    v_cvt_f32_i32 v156, v156
    v_cvt_f32_i32 v157, v157
    v_cvt_f32_i32 v158, v158
    v_cvt_f32_i32 v159, v159
    v_cvt_pk_bf16_f32 v164, v152, v153
    v_cvt_pk_bf16_f32 v165, v154, v155
    v_cvt_pk_bf16_f32 v166, v156, v157
    v_cvt_pk_bf16_f32 v167, v158, v159
    s_nop 1
    v_mfma_f32_16x16x32_bf16 v[168:171], v[164:167], v[124:127], v[168:171]
    s_waitcnt vmcnt(7)
    s_cmp_gt_i32 s83, 1
    s_cbranch_scc1 L_px49
    s_waitcnt vmcnt(6)
    s_cmp_ge_i32 s83, -1
    s_cbranch_scc1 L_px49
    s_waitcnt vmcnt(4)
L_px49:
    s_add_u32 m0, s71, 10240
    s_nop 0
    buffer_load_dwordx4 v194, s[8:11], s72 offen offset:0 nt lds
    s_nop 5
    s_mov_b32 exec_lo, 0xf000f0
    s_mov_b32 exec_hi, 0xf000f0
    v_sub_f32 v176, v168, v173
    v_sub_f32 v177, v169, v173
    v_sub_f32 v178, v170, v173
    v_sub_f32 v179, v171, v173
    s_mov_b64 exec, -1
    s_waitcnt vmcnt(7)
    s_cmp_gt_i32 s83, 5
    s_cbranch_scc1 L_px50
    s_waitcnt vmcnt(5)
L_px50:
    buffer_load_dwordx4 v195, s[8:11], s72 offen offset:1024 nt lds
    s_waitcnt vmcnt(6)
    s_cmp_gt_i32 s83, 3
    s_cbranch_scc1 L_px51
    s_waitcnt vmcnt(4)
L_px51:
    s_add_u32 m0, s71, 12288
    s_nop 0
    buffer_load_dwordx4 v196, s[8:11], s73 offen offset:0 nt lds
    s_waitcnt vmcnt(5)
    s_cmp_gt_i32 s83, 7
    s_cbranch_scc1 L_px52
    s_waitcnt vmcnt(4)
L_px52:
    buffer_load_dwordx4 v197, s[8:11], s73 offen offset:1024 nt lds
    v_mov_b32 v7, s91
    v_cmp_eq_u32 vcc, 0, v8
    s_lshl_b32 s81, s91, 4
    s_sub_i32 s81, 7, s81
    v_cndmask_b32 v8, v8, v7, vcc
    s_nop 1
    v_add_u32_dpp v8, v8, v8 row_ror:8 row_mask:0xf bank_mask:0xf
    s_nop 1
    v_add_u32_dpp v8, v8, v8 row_ror:4 row_mask:0xf bank_mask:0xf
    s_nop 1
    v_add_u32_dpp v8, v8, v8 row_ror:2 row_mask:0xf bank_mask:0xf
    s_nop 1
    v_add_u32_dpp v8, v8, v8 row_ror:1 row_mask:0xf bank_mask:0xf
    s_nop 0
    v_readfirstlane_b32 s83, v8
    s_add_i32 s83, s83, s81
    s_mul_i32 s83, s83, 24
    s_add_i32 s83, s83, s92
    s_ashr_i32 s83, s83, 6
    ds_read_b128 v[128:131], v200 offset:0
    ds_read_b128 v[132:135], v201 offset:0
    ds_read_b128 v[136:139], v202 offset:0
    ds_read_b128 v[140:143], v203 offset:0
    ds_read_b128 v[144:147], v204 offset:0
    ds_read_b128 v[148:151], v205 offset:0
    ds_read_b128 v[152:155], v206 offset:0
    ds_read_b128 v[156:159], v207 offset:0
    s_waitcnt lgkmcnt(0)
    s_waitcnt vmcnt(5)
    s_cmp_gt_i32 s83, 0
    s_cbranch_scc1 L_px53
    s_waitcnt vmcnt(4)
    s_cmp_ge_i32 s83, 0
    s_cbranch_scc1 L_px53
    s_waitcnt vmcnt(3)
L_px53:
    s_add_u32 m0, s71, 14336
    s_nop 0
    buffer_load_dwordx4 v198, s[8:11], s73 offen offset:0 nt lds
    v_cvt_f32_i32 v128, v128
    v_cvt_f32_i32 v129, v129
    v_cvt_f32_i32 v130, v130
    v_cvt_f32_i32 v131, v131
    v_cvt_f32_i32 v132, v132
    v_cvt_f32_i32 v133, v133
    v_cvt_f32_i32 v134, v134
    v_cvt_f32_i32 v135, v135
    v_cvt_pk_bf16_f32 v160, v128, v129
    v_cvt_pk_bf16_f32 v161, v130, v131
    v_cvt_pk_bf16_f32 v162, v132, v133
    v_cvt_pk_bf16_f32 v163, v134, v135
    s_nop 1
    v_mfma_f32_16x16x32_bf16 v[168:171], v[160:163], v[112:115], 0
    s_waitcnt vmcnt(5)
    s_cmp_gt_i32 s83, 4
    s_cbranch_scc1 L_px54
    s_waitcnt vmcnt(4)
L_px54:
    buffer_load_dwordx4 v199, s[8:11], s73 offen offset:1024 nt lds
    v_cvt_f32_i32 v136, v136
    v_cvt_f32_i32 v137, v137
    v_cvt_f32_i32 v138, v138
    v_cvt_f32_i32 v139, v139
    v_cvt_f32_i32 v140, v140
    v_cvt_f32_i32 v141, v141
    v_cvt_f32_i32 v142, v142
    v_cvt_f32_i32 v143, v143
    v_cvt_pk_bf16_f32 v164, v136, v137
    v_cvt_pk_bf16_f32 v165, v138, v139
    v_cvt_pk_bf16_f32 v166, v140, v141
    v_cvt_pk_bf16_f32 v167, v142, v143
    s_nop 1
    v_mfma_f32_16x16x32_bf16 v[168:171], v[164:167], v[116:119], v[168:171]
    s_waitcnt vmcnt(5)
    s_cmp_gt_i32 s83, 2
    s_cbranch_scc1 L_px55
    s_waitcnt vmcnt(4)
L_px55:
    s_and_b32 s80, s79, 31
    s_lshl_b32 s80, s80, 16
    s_add_u32 s72, s80, s78
    s_xor_b32 s73, s72, 4096
    s_add_u32 s79, s79, 1
    buffer_load_dwordx4 v[16:19], v1, s[12:15], s72 offen nt
    v_cvt_f32_i32 v144, v144
    v_cvt_f32_i32 v145, v145
    v_cvt_f32_i32 v146, v146
    v_cvt_f32_i32 v147, v147
    v_cvt_f32_i32 v148, v148
    v_cvt_f32_i32 v149, v149
    v_cvt_f32_i32 v150, v150
    v_cvt_f32_i32 v151, v151
    v_cvt_pk_bf16_f32 v160, v144, v145
    v_cvt_pk_bf16_f32 v161, v146, v147
    v_cvt_pk_bf16_f32 v162, v148, v149
    v_cvt_pk_bf16_f32 v163, v150, v151
    s_nop 1
    v_mfma_f32_16x16x32_bf16 v[168:171], v[160:163], v[120:123], v[168:171]
    s_waitcnt vmcnt(5)
    s_cmp_gt_i32 s83, 6
    s_cbranch_scc1 L_px56
    s_waitcnt vmcnt(4)
L_px56:
    buffer_load_dwordx4 v[20:23], v190, s[12:15], s72 offen nt
    v_cvt_f32_i32 v152, v152
    v_cvt_f32_i32 v153, v153
    v_cvt_f32_i32 v154, v154
    v_cvt_f32_i32 v155, v155
    v_cvt_f32_i32 v156, v156
    v_cvt_f32_i32 v157, v157
    v_cvt_f32_i32 v158, v158
    v_cvt_f32_i32 v159, v159
    v_cvt_pk_bf16_f32 v164, v152, v153
    v_cvt_pk_bf16_f32 v165, v154, v155
    v_cvt_pk_bf16_f32 v166, v156, v157
    v_cvt_pk_bf16_f32 v167, v158, v159
    s_nop 1
    v_mfma_f32_16x16x32_bf16 v[168:171], v[164:167], v[124:127], v[168:171]
    s_waitcnt vmcnt(5)
    s_cmp_gt_i32 s83, 1
    s_cbranch_scc1 L_px57
    s_waitcnt vmcnt(4)
    s_cmp_ge_i32 s83, -1
    s_cbranch_scc1 L_px57
    s_waitcnt vmcnt(3)
L_px57:
    buffer_load_dwordx4 v[24:27], v1, s[12:15], s73 offen nt
    s_nop 5
    s_mov_b32 exec_lo, 0xf000f00
    s_mov_b32 exec_hi, 0xf000f00
    v_sub_f32 v176, v168, v174
    v_sub_f32 v177, v169, v174
    v_sub_f32 v178, v170, v174
    v_sub_f32 v179, v171, v174
    s_mov_b64 exec, -1
    s_waitcnt vmcnt(5)
    s_cmp_gt_i32 s83, 5
    s_cbranch_scc1 L_px58
    s_waitcnt vmcnt(4)
L_px58:
    buffer_load_dwordx4 v[28:31], v190, s[12:15], s73 offen nt
    s_waitcnt vmcnt(5)
    s_cmp_gt_i32 s83, 3
    s_cbranch_scc1 L_px59
    s_waitcnt vmcnt(4)
L_px59:
    buffer_load_dwordx4 v[32:35], v191, s[12:15], s72 offen nt
    s_waitcnt vmcnt(5)
    s_cmp_gt_i32 s83, 7
    s_cbranch_scc1 L_px60
    s_waitcnt vmcnt(4)
L_px60:
    buffer_load_dwordx4 v[36:39], v208, s[12:15], s72 offen nt
    s_add_u32 s90, s90, 1
    v_mov_b32 v7, s90
    s_mov_b64 exec, 1
    buffer_store_byte v7, v0, s[44:47], s94 offen
    s_mov_b64 exec, -1
    ds_read_b128 v[128:131], v200 offset:8192
    ds_read_b128 v[132:135], v201 offset:8192
    ds_read_b128 v[136:139], v202 offset:8192
    ds_read_b128 v[140:143], v203 offset:8192
    ds_read_b128 v[144:147], v204 offset:8192
    ds_read_b128 v[148:151], v205 offset:8192
    ds_read_b128 v[152:155], v206 offset:8192
    ds_read_b128 v[156:159], v207 offset:8192
    s_waitcnt lgkmcnt(0)
    s_waitcnt vmcnt(6)
    s_cmp_gt_i32 s83, 0
    s_cbranch_scc1 L_px61
    s_waitcnt vmcnt(5)
    s_cmp_ge_i32 s83, 0
    s_cbranch_scc1 L_px61
    s_waitcnt vmcnt(4)
L_px61:
    buffer_load_dwordx4 v[40:43], v191, s[12:15], s73 offen nt
    s_mov_b32 s91, s90
    buffer_load_ubyte v8, v13, s[44:47], s95 offen nt
    v_cvt_f32_i32 v128, v128
    v_cvt_f32_i32 v129, v129
    v_cvt_f32_i32 v130, v130
    v_cvt_f32_i32 v131, v131
    v_cvt_f32_i32 v132, v132
    v_cvt_f32_i32 v133, v133
    v_cvt_f32_i32 v134, v134
    v_cvt_f32_i32 v135, v135
    v_cvt_pk_bf16_f32 v160, v128, v129
    v_cvt_pk_bf16_f32 v161, v130, v131
    v_cvt_pk_bf16_f32 v162, v132, v133
    v_cvt_pk_bf16_f32 v163, v134, v135
    s_nop 1
    v_mfma_f32_16x16x32_bf16 v[168:171], v[160:163], v[112:115], 0
    s_waitcnt vmcnt(7)
    s_cmp_gt_i32 s83, 4
    s_cbranch_scc1 L_px62
    s_waitcnt vmcnt(6)
L_px62:
    buffer_load_dwordx4 v[44:47], v208, s[12:15], s73 offen nt
    v_cvt_f32_i32 v136, v136
    v_cvt_f32_i32 v137, v137
    v_cvt_f32_i32 v138, v138
    v_cvt_f32_i32 v139, v139
    v_cvt_f32_i32 v140, v140
    v_cvt_f32_i32 v141, v141
    v_cvt_f32_i32 v142, v142
    v_cvt_f32_i32 v143, v143
    v_cvt_pk_bf16_f32 v164, v136, v137
    v_cvt_pk_bf16_f32 v165, v138, v139
    v_cvt_pk_bf16_f32 v166, v140, v141
    v_cvt_pk_bf16_f32 v167, v142, v143
    s_nop 1
    v_mfma_f32_16x16x32_bf16 v[168:171], v[164:167], v[116:119], v[168:171]
    s_waitcnt vmcnt(7)
    s_cmp_gt_i32 s83, 2
    s_cbranch_scc1 L_px63
    s_waitcnt vmcnt(6)
L_px63:
    s_and_b32 s80, s79, 31
    s_lshl_b32 s80, s80, 16
    s_add_u32 s72, s80, s78
    s_xor_b32 s73, s72, 4096
    s_add_u32 s79, s79, 1
    buffer_load_dwordx4 v[48:51], v1, s[12:15], s72 offen nt
    v_cvt_f32_i32 v144, v144
    v_cvt_f32_i32 v145, v145
    v_cvt_f32_i32 v146, v146
    v_cvt_f32_i32 v147, v147
    v_cvt_f32_i32 v148, v148
    v_cvt_f32_i32 v149, v149
    v_cvt_f32_i32 v150, v150
    v_cvt_f32_i32 v151, v151
    v_cvt_pk_bf16_f32 v160, v144, v145
    v_cvt_pk_bf16_f32 v161, v146, v147
    v_cvt_pk_bf16_f32 v162, v148, v149
    v_cvt_pk_bf16_f32 v163, v150, v151
    s_nop 1
    v_mfma_f32_16x16x32_bf16 v[168:171], v[160:163], v[120:123], v[168:171]
    s_waitcnt vmcnt(7)
    s_cmp_gt_i32 s83, 6
    s_cbranch_scc1 L_px64
    s_waitcnt vmcnt(6)
L_px64:
    buffer_load_dwordx4 v[52:55], v190, s[12:15], s72 offen nt
    v_cvt_f32_i32 v152, v152
    v_cvt_f32_i32 v153, v153
    v_cvt_f32_i32 v154, v154
    v_cvt_f32_i32 v155, v155
    v_cvt_f32_i32 v156, v156
    v_cvt_f32_i32 v157, v157
    v_cvt_f32_i32 v158, v158
    v_cvt_f32_i32 v159, v159
    v_cvt_pk_bf16_f32 v164, v152, v153
    v_cvt_pk_bf16_f32 v165, v154, v155
    v_cvt_pk_bf16_f32 v166, v156, v157
    v_cvt_pk_bf16_f32 v167, v158, v159
    s_nop 1
    v_mfma_f32_16x16x32_bf16 v[168:171], v[164:167], v[124:127], v[168:171]
    s_nop 5
    s_mov_b32 exec_lo, 0xf000f000
    s_mov_b32 exec_hi, 0xf000f000
    v_sub_f32 v176, v168, v175
    v_sub_f32 v177, v169, v175
    v_sub_f32 v178, v170, v175
    v_sub_f32 v179, v171, v175
    s_mov_b64 exec, -1
    ds_write_b128 v14, v[176:179]
    v_max3_f32 v5, v5, v176, v177
    v_max3_f32 v5, v5, v178, v179
    v_subrev_u32 v14, 7168, v14
    v_mov_b32 v10, v5
    v_and_b32 v9, 3, v0
    v_lshlrev_b32 v9, 2, v9
    v_permlane32_swap_b32 v5, v10
    v_max_f32 v5, v5, v10
    v_mov_b32 v10, v5
    s_lshl_b32 s80, s3, 4
    v_add_u32 v11, s80, v9
    v_permlane16_swap_b32 v5, v10
    v_max_f32 v5, v5, v10
    v_mov_b32 v80, 0
    v_mov_b32 v81, 0
    v_max_f32_dpp v5, v5, v5 row_ror:4 row_mask:0xf bank_mask:0xf
    v_mov_b32 v82, 0
    v_mov_b32 v83, 0
    v_max_f32_dpp v5, v5, v5 row_ror:8 row_mask:0xf bank_mask:0xf
    ds_write_b32 v11, v5 offset:41088
    v_mov_b32 v84, 0
    v_mov_b32 v85, 0
    v_mov_b32 v86, 0
    v_mov_b32 v87, 0
    v_mov_b32 v88, 0
    v_mov_b32 v89, 0
    v_mov_b32 v90, 0
    v_mov_b32 v91, 0
    v_mov_b32 v92, 0
    v_mov_b32 v93, 0
    v_mov_b32 v94, 0
    v_mov_b32 v95, 0
    v_mov_b32 v96, 0
    v_mov_b32 v97, 0
    v_mov_b32 v98, 0
    v_mov_b32 v99, 0
    v_mov_b32 v100, 0
    v_mov_b32 v101, 0
    v_mov_b32 v102, 0
    v_mov_b32 v103, 0
    v_mov_b32 v104, 0
    v_mov_b32 v105, 0
    v_mov_b32 v106, 0
    v_mov_b32 v107, 0
    v_mov_b32 v108, 0
    v_mov_b32 v109, 0
    v_mov_b32 v110, 0
    v_mov_b32 v111, 0
    v_mov_b32 v112, 0
    v_mov_b32 v113, 0
    v_mov_b32 v114, 0
    v_mov_b32 v115, 0
    v_add_u32 v12, 40960, v9
    s_waitcnt lgkmcnt(0)
    s_barrier
    ds_read2_b32 v[160:161], v12 offset0:32 offset1:36
    ds_read2_b32 v[162:163], v12 offset0:40 offset1:44
    ds_read_b128 v[176:179], v14
    ds_read_b64 v[188:189], v4 offset:32768
    ds_read2_b64 a[16:19], v15 offset1:16
    ds_read2_b64 a[20:23], v15 offset0:32 offset1:48
    s_waitcnt lgkmcnt(4)
    v_max3_f32 v5, v160, v161, v162
    v_max_f32 v5, v5, v163
    v_mul_f32 v5, s77, v5
L_vloop:
    s_waitcnt vmcnt(7)
    s_cmp_gt_i32 s83, 1
    s_cbranch_scc1 L_px65
    s_waitcnt vmcnt(6)
    s_cmp_ge_i32 s83, -1
    s_cbranch_scc1 L_px65
    s_waitcnt vmcnt(4)
L_px65:
    buffer_load_dwordx4 v[56:59], v1, s[12:15], s73 offen nt
    s_waitcnt lgkmcnt(0)
    v_fma_f32 v176, v176, s77, -v5
    v_fma_f32 v177, v177, s77, -v5
    v_fma_f32 v178, v178, s77, -v5
    v_fma_f32 v179, v179, s77, -v5
    v_exp_f32 v176, v176
    v_exp_f32 v177, v177
    v_exp_f32 v178, v178
    v_exp_f32 v179, v179
    v_lshlrev_b32 v180, 16, v188
    v_and_b32 v181, s82, v188
    v_lshlrev_b32 v182, 16, v189
    v_and_b32 v183, s82, v189
    v_mul_f32 v180, v180, v176
    v_mul_f32 v181, v181, v177
    v_mul_f32 v182, v182, v178
    v_mul_f32 v183, v183, v179
    v_cvt_pk_bf16_f32 v184, v180, v181
    v_cvt_pk_bf16_f32 v185, v182, v183
    v_add_f32 v6, v6, v176
    v_add_f32 v6, v6, v177
    v_add_f32 v6, v6, v178
    v_add_f32 v6, v6, v179
    s_waitcnt vmcnt(7)
    s_cmp_gt_i32 s83, 5
    s_cbranch_scc1 L_px66
    s_waitcnt vmcnt(5)
L_px66:
    buffer_load_dwordx4 v[60:63], v190, s[12:15], s73 offen nt
    s_waitcnt vmcnt(6)
    s_cmp_gt_i32 s83, 3
    s_cbranch_scc1 L_px67
    s_waitcnt vmcnt(4)
L_px67:
    buffer_load_dwordx4 v[64:67], v191, s[12:15], s72 offen nt
    s_waitcnt vmcnt(5)
    s_cmp_gt_i32 s83, 7
    s_cbranch_scc1 L_px68
    s_waitcnt vmcnt(4)
L_px68:
    buffer_load_dwordx4 v[68:71], v208, s[12:15], s72 offen nt
    v_mov_b32 v7, s91
    v_cmp_eq_u32 vcc, 0, v8
    s_lshl_b32 s81, s91, 4
    s_sub_i32 s81, 7, s81
    v_cndmask_b32 v8, v8, v7, vcc
    s_nop 1
    v_add_u32_dpp v8, v8, v8 row_ror:8 row_mask:0xf bank_mask:0xf
    s_nop 1
    v_add_u32_dpp v8, v8, v8 row_ror:4 row_mask:0xf bank_mask:0xf
    s_nop 1
    v_add_u32_dpp v8, v8, v8 row_ror:2 row_mask:0xf bank_mask:0xf
    s_nop 1
    v_add_u32_dpp v8, v8, v8 row_ror:1 row_mask:0xf bank_mask:0xf
    s_nop 0
    v_readfirstlane_b32 s83, v8
    s_add_i32 s83, s83, s81
    s_mul_i32 s83, s83, 24
    s_add_i32 s83, s83, s92
    s_ashr_i32 s83, s83, 6
    v_mov_b32_dpp v186, v184 quad_perm:[0,1,2,3] row_mask:0xf bank_mask:0x1
    v_mov_b32_dpp v187, v185 quad_perm:[0,1,2,3] row_mask:0xf bank_mask:0x1
    v_cvt_f32_i32 v16, v16
    v_cvt_f32_i32 v20, v20
    v_cvt_f32_i32 v24, v24
    v_cvt_f32_i32 v28, v28
    v_cvt_pk_bf16_f32 v160, v16, v20
    v_cvt_pk_bf16_f32 v161, v24, v28
    v_mfma_f32_16x16x16_bf16 v[112:115], a[16:17], v[186:187], v[112:115]
    v_cvt_f32_i32 v17, v17
    v_cvt_f32_i32 v21, v21
    v_cvt_f32_i32 v25, v25
    v_cvt_f32_i32 v29, v29
    v_cvt_pk_bf16_f32 v162, v17, v21
    v_cvt_pk_bf16_f32 v163, v25, v29
    v_mfma_f32_16x16x16_bf16 v[80:83], v[160:161], v[186:187], v[80:83]
    v_cvt_f32_i32 v18, v18
    v_cvt_f32_i32 v22, v22
    v_cvt_f32_i32 v26, v26
    v_cvt_f32_i32 v30, v30
    v_cvt_pk_bf16_f32 v164, v18, v22
    v_cvt_pk_bf16_f32 v165, v26, v30
    v_mfma_f32_16x16x16_bf16 v[84:87], v[162:163], v[186:187], v[84:87]
    v_cvt_f32_i32 v19, v19
    v_cvt_f32_i32 v23, v23
    v_cvt_f32_i32 v27, v27
    v_cvt_f32_i32 v31, v31
    v_cvt_pk_bf16_f32 v166, v19, v23
    v_cvt_pk_bf16_f32 v167, v27, v31
    v_mfma_f32_16x16x16_bf16 v[88:91], v[164:165], v[186:187], v[88:91]
    s_nop 0
    v_mfma_f32_16x16x16_bf16 v[92:95], v[166:167], v[186:187], v[92:95]
    s_waitcnt vmcnt(5)
    s_cmp_gt_i32 s83, 0
    s_cbranch_scc1 L_px69
    s_waitcnt vmcnt(4)
    s_cmp_ge_i32 s83, 0
    s_cbranch_scc1 L_px69
    s_waitcnt vmcnt(3)
L_px69:
    buffer_load_dwordx4 v[72:75], v191, s[12:15], s73 offen nt
    v_cvt_f32_i32 v32, v32
    v_cvt_f32_i32 v36, v36
    v_cvt_f32_i32 v40, v40
    v_cvt_f32_i32 v44, v44
    v_cvt_pk_bf16_f32 v160, v32, v36
    v_cvt_pk_bf16_f32 v161, v40, v44
    v_cvt_f32_i32 v33, v33
    v_cvt_f32_i32 v37, v37
    v_cvt_f32_i32 v41, v41
    v_cvt_f32_i32 v45, v45
    v_cvt_pk_bf16_f32 v162, v33, v37
    v_cvt_pk_bf16_f32 v163, v41, v45
    v_mfma_f32_16x16x16_bf16 v[96:99], v[160:161], v[186:187], v[96:99]
    v_cvt_f32_i32 v34, v34
    v_cvt_f32_i32 v38, v38
    v_cvt_f32_i32 v42, v42
    v_cvt_f32_i32 v46, v46
    v_cvt_pk_bf16_f32 v164, v34, v38
    v_cvt_pk_bf16_f32 v165, v42, v46
    v_mfma_f32_16x16x16_bf16 v[100:103], v[162:163], v[186:187], v[100:103]
    v_cvt_f32_i32 v35, v35
    v_cvt_f32_i32 v39, v39
    v_cvt_f32_i32 v43, v43
    v_cvt_f32_i32 v47, v47
    v_cvt_pk_bf16_f32 v166, v35, v39
    v_cvt_pk_bf16_f32 v167, v43, v47
    v_mfma_f32_16x16x16_bf16 v[104:107], v[164:165], v[186:187], v[104:107]
    s_nop 0
    v_mfma_f32_16x16x16_bf16 v[108:111], v[166:167], v[186:187], v[108:111]
    s_waitcnt vmcnt(5)
    s_cmp_gt_i32 s83, 4
    s_cbranch_scc1 L_px70
    s_waitcnt vmcnt(4)
L_px70:
    buffer_load_dwordx4 v[76:79], v208, s[12:15], s73 offen nt
    s_waitcnt vmcnt(5)
    s_cmp_gt_i32 s83, 2
    s_cbranch_scc1 L_px71
    s_waitcnt vmcnt(4)
L_px71:
    s_and_b32 s80, s79, 31
    s_lshl_b32 s80, s80, 16
    s_add_u32 s72, s80, s78
    s_xor_b32 s73, s72, 4096
    s_add_u32 s79, s79, 1
    buffer_load_dwordx4 v[16:19], v1, s[12:15], s72 offen nt
    s_waitcnt vmcnt(5)
    s_cmp_gt_i32 s83, 6
    s_cbranch_scc1 L_px72
    s_waitcnt vmcnt(4)
L_px72:
    buffer_load_dwordx4 v[20:23], v190, s[12:15], s72 offen nt
    s_waitcnt vmcnt(5)
    s_cmp_gt_i32 s83, 1
    s_cbranch_scc1 L_px73
    s_waitcnt vmcnt(4)
    s_cmp_ge_i32 s83, -1
    s_cbranch_scc1 L_px73
    s_waitcnt vmcnt(3)
L_px73:
    buffer_load_dwordx4 v[24:27], v1, s[12:15], s73 offen nt
    s_waitcnt vmcnt(5)
    s_cmp_gt_i32 s83, 5
    s_cbranch_scc1 L_px74
    s_waitcnt vmcnt(4)
L_px74:
    buffer_load_dwordx4 v[28:31], v190, s[12:15], s73 offen nt
    s_waitcnt vmcnt(5)
    s_cmp_gt_i32 s83, 3
    s_cbranch_scc1 L_px75
    s_waitcnt vmcnt(4)
L_px75:
    buffer_load_dwordx4 v[32:35], v191, s[12:15], s72 offen nt
    s_waitcnt vmcnt(5)
    s_cmp_gt_i32 s83, 7
    s_cbranch_scc1 L_px76
    s_waitcnt vmcnt(4)
L_px76:
    buffer_load_dwordx4 v[36:39], v208, s[12:15], s72 offen nt
    s_add_u32 s90, s90, 1
    v_mov_b32 v7, s90
    s_mov_b64 exec, 1
    buffer_store_byte v7, v0, s[44:47], s94 offen
    s_mov_b64 exec, -1
    v_mov_b32_dpp v186, v184 row_shl:4 row_mask:0xf bank_mask:0x1
    v_mov_b32_dpp v187, v185 row_shl:4 row_mask:0xf bank_mask:0x1
    v_cvt_f32_i32 v48, v48
    v_cvt_f32_i32 v52, v52
    v_cvt_f32_i32 v56, v56
    v_cvt_f32_i32 v60, v60
    v_cvt_pk_bf16_f32 v160, v48, v52
    v_cvt_pk_bf16_f32 v161, v56, v60
    v_mfma_f32_16x16x16_bf16 v[112:115], a[18:19], v[186:187], v[112:115]
    v_cvt_f32_i32 v49, v49
    v_cvt_f32_i32 v53, v53
    v_cvt_f32_i32 v57, v57
    v_cvt_f32_i32 v61, v61
    v_cvt_pk_bf16_f32 v162, v49, v53
    v_cvt_pk_bf16_f32 v163, v57, v61
    v_mfma_f32_16x16x16_bf16 v[80:83], v[160:161], v[186:187], v[80:83]
    v_cvt_f32_i32 v50, v50
    v_cvt_f32_i32 v54, v54
    v_cvt_f32_i32 v58, v58
    v_cvt_f32_i32 v62, v62
    v_cvt_pk_bf16_f32 v164, v50, v54
    v_cvt_pk_bf16_f32 v165, v58, v62
    v_mfma_f32_16x16x16_bf16 v[84:87], v[162:163], v[186:187], v[84:87]
    v_cvt_f32_i32 v51, v51
    v_cvt_f32_i32 v55, v55
    v_cvt_f32_i32 v59, v59
    v_cvt_f32_i32 v63, v63
    v_cvt_pk_bf16_f32 v166, v51, v55
    v_cvt_pk_bf16_f32 v167, v59, v63
    v_mfma_f32_16x16x16_bf16 v[88:91], v[164:165], v[186:187], v[88:91]
    s_nop 0
    v_mfma_f32_16x16x16_bf16 v[92:95], v[166:167], v[186:187], v[92:95]
    s_waitcnt vmcnt(6)
    s_cmp_gt_i32 s83, 0
    s_cbranch_scc1 L_px77
    s_waitcnt vmcnt(5)
    s_cmp_ge_i32 s83, 0
    s_cbranch_scc1 L_px77
    s_waitcnt vmcnt(4)
L_px77:
    buffer_load_dwordx4 v[40:43], v191, s[12:15], s73 offen nt
    s_mov_b32 s91, s90
    buffer_load_ubyte v8, v13, s[44:47], s95 offen nt
    v_cvt_f32_i32 v64, v64
    v_cvt_f32_i32 v68, v68
    v_cvt_f32_i32 v72, v72
    v_cvt_f32_i32 v76, v76
    v_cvt_pk_bf16_f32 v160, v64, v68
    v_cvt_pk_bf16_f32 v161, v72, v76
    v_cvt_f32_i32 v65, v65
    v_cvt_f32_i32 v69, v69
    v_cvt_f32_i32 v73, v73
    v_cvt_f32_i32 v77, v77
    v_cvt_pk_bf16_f32 v162, v65, v69
    v_cvt_pk_bf16_f32 v163, v73, v77
    v_mfma_f32_16x16x16_bf16 v[96:99], v[160:161], v[186:187], v[96:99]
    v_cvt_f32_i32 v66, v66
    v_cvt_f32_i32 v70, v70
    v_cvt_f32_i32 v74, v74
    v_cvt_f32_i32 v78, v78
    v_cvt_pk_bf16_f32 v164, v66, v70
    v_cvt_pk_bf16_f32 v165, v74, v78
    v_mfma_f32_16x16x16_bf16 v[100:103], v[162:163], v[186:187], v[100:103]
    v_cvt_f32_i32 v67, v67
    v_cvt_f32_i32 v71, v71
    v_cvt_f32_i32 v75, v75
    v_cvt_f32_i32 v79, v79
    v_cvt_pk_bf16_f32 v166, v67, v71
    v_cvt_pk_bf16_f32 v167, v75, v79
    v_mfma_f32_16x16x16_bf16 v[104:107], v[164:165], v[186:187], v[104:107]
    s_nop 0
    v_mfma_f32_16x16x16_bf16 v[108:111], v[166:167], v[186:187], v[108:111]
    s_waitcnt vmcnt(7)
    s_cmp_gt_i32 s83, 4
    s_cbranch_scc1 L_px78
    s_waitcnt vmcnt(6)
L_px78:
    buffer_load_dwordx4 v[44:47], v208, s[12:15], s73 offen nt
    s_waitcnt vmcnt(7)
    s_cmp_gt_i32 s83, 2
    s_cbranch_scc1 L_px79
    s_waitcnt vmcnt(6)
L_px79:
    s_and_b32 s80, s79, 31
    s_lshl_b32 s80, s80, 16
    s_add_u32 s72, s80, s78
    s_xor_b32 s73, s72, 4096
    s_add_u32 s79, s79, 1
    buffer_load_dwordx4 v[48:51], v1, s[12:15], s72 offen nt
    s_waitcnt vmcnt(7)
    s_cmp_gt_i32 s83, 6
    s_cbranch_scc1 L_px80
    s_waitcnt vmcnt(6)
L_px80:
    buffer_load_dwordx4 v[52:55], v190, s[12:15], s72 offen nt
    s_waitcnt vmcnt(7)
    s_cmp_gt_i32 s83, 1
    s_cbranch_scc1 L_px81
    s_waitcnt vmcnt(6)
    s_cmp_ge_i32 s83, -1
    s_cbranch_scc1 L_px81
    s_waitcnt vmcnt(4)
L_px81:
    buffer_load_dwordx4 v[56:59], v1, s[12:15], s73 offen nt
    s_waitcnt vmcnt(7)
    s_cmp_gt_i32 s83, 5
    s_cbranch_scc1 L_px82
    s_waitcnt vmcnt(5)
L_px82:
    buffer_load_dwordx4 v[60:63], v190, s[12:15], s73 offen nt
    s_waitcnt vmcnt(6)
    s_cmp_gt_i32 s83, 3
    s_cbranch_scc1 L_px83
    s_waitcnt vmcnt(4)
L_px83:
    buffer_load_dwordx4 v[64:67], v191, s[12:15], s72 offen nt
    s_waitcnt vmcnt(5)
    s_cmp_gt_i32 s83, 7
    s_cbranch_scc1 L_px84
    s_waitcnt vmcnt(4)
L_px84:
    buffer_load_dwordx4 v[68:71], v208, s[12:15], s72 offen nt
    v_mov_b32 v7, s91
    v_cmp_eq_u32 vcc, 0, v8
    s_lshl_b32 s81, s91, 4
    s_sub_i32 s81, 7, s81
    v_cndmask_b32 v8, v8, v7, vcc
    s_nop 1
    v_add_u32_dpp v8, v8, v8 row_ror:8 row_mask:0xf bank_mask:0xf
    s_nop 1
    v_add_u32_dpp v8, v8, v8 row_ror:4 row_mask:0xf bank_mask:0xf
    s_nop 1
    v_add_u32_dpp v8, v8, v8 row_ror:2 row_mask:0xf bank_mask:0xf
    s_nop 1
    v_add_u32_dpp v8, v8, v8 row_ror:1 row_mask:0xf bank_mask:0xf
    s_nop 0
    v_readfirstlane_b32 s83, v8
    s_add_i32 s83, s83, s81
    s_mul_i32 s83, s83, 24
    s_add_i32 s83, s83, s92
    s_ashr_i32 s83, s83, 6
    v_mov_b32_dpp v186, v184 row_shl:8 row_mask:0xf bank_mask:0x1
    v_mov_b32_dpp v187, v185 row_shl:8 row_mask:0xf bank_mask:0x1
    v_cvt_f32_i32 v16, v16
    v_cvt_f32_i32 v20, v20
    v_cvt_f32_i32 v24, v24
    v_cvt_f32_i32 v28, v28
    v_cvt_pk_bf16_f32 v160, v16, v20
    v_cvt_pk_bf16_f32 v161, v24, v28
    v_mfma_f32_16x16x16_bf16 v[112:115], a[20:21], v[186:187], v[112:115]
    v_cvt_f32_i32 v17, v17
    v_cvt_f32_i32 v21, v21
    v_cvt_f32_i32 v25, v25
    v_cvt_f32_i32 v29, v29
    v_cvt_pk_bf16_f32 v162, v17, v21
    v_cvt_pk_bf16_f32 v163, v25, v29
    v_mfma_f32_16x16x16_bf16 v[80:83], v[160:161], v[186:187], v[80:83]
    v_cvt_f32_i32 v18, v18
    v_cvt_f32_i32 v22, v22
    v_cvt_f32_i32 v26, v26
    v_cvt_f32_i32 v30, v30
    v_cvt_pk_bf16_f32 v164, v18, v22
    v_cvt_pk_bf16_f32 v165, v26, v30
    v_mfma_f32_16x16x16_bf16 v[84:87], v[162:163], v[186:187], v[84:87]
    v_cvt_f32_i32 v19, v19
    v_cvt_f32_i32 v23, v23
    v_cvt_f32_i32 v27, v27
    v_cvt_f32_i32 v31, v31
    v_cvt_pk_bf16_f32 v166, v19, v23
    v_cvt_pk_bf16_f32 v167, v27, v31
    v_mfma_f32_16x16x16_bf16 v[88:91], v[164:165], v[186:187], v[88:91]
    s_nop 0
    v_mfma_f32_16x16x16_bf16 v[92:95], v[166:167], v[186:187], v[92:95]
    s_waitcnt vmcnt(5)
    s_cmp_gt_i32 s83, 0
    s_cbranch_scc1 L_px85
    s_waitcnt vmcnt(4)
    s_cmp_ge_i32 s83, 0
    s_cbranch_scc1 L_px85
    s_waitcnt vmcnt(3)
L_px85:
    buffer_load_dwordx4 v[72:75], v191, s[12:15], s73 offen nt
    v_cvt_f32_i32 v32, v32
    v_cvt_f32_i32 v36, v36
    v_cvt_f32_i32 v40, v40
    v_cvt_f32_i32 v44, v44
    v_cvt_pk_bf16_f32 v160, v32, v36
    v_cvt_pk_bf16_f32 v161, v40, v44
    v_cvt_f32_i32 v33, v33
    v_cvt_f32_i32 v37, v37
    v_cvt_f32_i32 v41, v41
    v_cvt_f32_i32 v45, v45
    v_cvt_pk_bf16_f32 v162, v33, v37
    v_cvt_pk_bf16_f32 v163, v41, v45
    v_mfma_f32_16x16x16_bf16 v[96:99], v[160:161], v[186:187], v[96:99]
    v_cvt_f32_i32 v34, v34
    v_cvt_f32_i32 v38, v38
    v_cvt_f32_i32 v42, v42
    v_cvt_f32_i32 v46, v46
    v_cvt_pk_bf16_f32 v164, v34, v38
    v_cvt_pk_bf16_f32 v165, v42, v46
    v_mfma_f32_16x16x16_bf16 v[100:103], v[162:163], v[186:187], v[100:103]
    v_cvt_f32_i32 v35, v35
    v_cvt_f32_i32 v39, v39
    v_cvt_f32_i32 v43, v43
    v_cvt_f32_i32 v47, v47
    v_cvt_pk_bf16_f32 v166, v35, v39
    v_cvt_pk_bf16_f32 v167, v43, v47
    v_mfma_f32_16x16x16_bf16 v[104:107], v[164:165], v[186:187], v[104:107]
    s_nop 0
    v_mfma_f32_16x16x16_bf16 v[108:111], v[166:167], v[186:187], v[108:111]
    s_waitcnt vmcnt(5)
    s_cmp_gt_i32 s83, 4
    s_cbranch_scc1 L_px86
    s_waitcnt vmcnt(4)
L_px86:
    buffer_load_dwordx4 v[76:79], v208, s[12:15], s73 offen nt
    s_waitcnt vmcnt(5)
    s_cmp_gt_i32 s83, 2
    s_cbranch_scc1 L_px87
    s_waitcnt vmcnt(4)
L_px87:
    s_and_b32 s80, s79, 31
    s_lshl_b32 s80, s80, 16
    s_add_u32 s72, s80, s78
    s_xor_b32 s73, s72, 4096
    s_add_u32 s79, s79, 1
    buffer_load_dwordx4 v[16:19], v1, s[12:15], s72 offen nt
    s_waitcnt vmcnt(5)
    s_cmp_gt_i32 s83, 6
    s_cbranch_scc1 L_px88
    s_waitcnt vmcnt(4)
L_px88:
    buffer_load_dwordx4 v[20:23], v190, s[12:15], s72 offen nt
    s_waitcnt vmcnt(5)
    s_cmp_gt_i32 s83, 1
    s_cbranch_scc1 L_px89
    s_waitcnt vmcnt(4)
    s_cmp_ge_i32 s83, -1
    s_cbranch_scc1 L_px89
    s_waitcnt vmcnt(3)
L_px89:
    buffer_load_dwordx4 v[24:27], v1, s[12:15], s73 offen nt
    s_waitcnt vmcnt(5)
    s_cmp_gt_i32 s83, 5
    s_cbranch_scc1 L_px90
    s_waitcnt vmcnt(4)
L_px90:
    buffer_load_dwordx4 v[28:31], v190, s[12:15], s73 offen nt
    s_waitcnt vmcnt(5)
    s_cmp_gt_i32 s83, 3
    s_cbranch_scc1 L_px91
    s_waitcnt vmcnt(4)
L_px91:
    buffer_load_dwordx4 v[32:35], v191, s[12:15], s72 offen nt
    s_waitcnt vmcnt(5)
    s_cmp_gt_i32 s83, 7
    s_cbranch_scc1 L_px92
    s_waitcnt vmcnt(4)
L_px92:
    buffer_load_dwordx4 v[36:39], v208, s[12:15], s72 offen nt
    s_add_u32 s90, s90, 1
    v_mov_b32 v7, s90
    s_mov_b64 exec, 1
    buffer_store_byte v7, v0, s[44:47], s94 offen
    s_mov_b64 exec, -1
    v_mov_b32_dpp v186, v184 row_shl:12 row_mask:0xf bank_mask:0x1
    v_mov_b32_dpp v187, v185 row_shl:12 row_mask:0xf bank_mask:0x1
    v_cvt_f32_i32 v48, v48
    v_cvt_f32_i32 v52, v52
    v_cvt_f32_i32 v56, v56
    v_cvt_f32_i32 v60, v60
    v_cvt_pk_bf16_f32 v160, v48, v52
    v_cvt_pk_bf16_f32 v161, v56, v60
    v_mfma_f32_16x16x16_bf16 v[112:115], a[22:23], v[186:187], v[112:115]
    v_cvt_f32_i32 v49, v49
    v_cvt_f32_i32 v53, v53
    v_cvt_f32_i32 v57, v57
    v_cvt_f32_i32 v61, v61
    v_cvt_pk_bf16_f32 v162, v49, v53
    v_cvt_pk_bf16_f32 v163, v57, v61
    v_mfma_f32_16x16x16_bf16 v[80:83], v[160:161], v[186:187], v[80:83]
    v_cvt_f32_i32 v50, v50
    v_cvt_f32_i32 v54, v54
    v_cvt_f32_i32 v58, v58
    v_cvt_f32_i32 v62, v62
    v_cvt_pk_bf16_f32 v164, v50, v54
    v_cvt_pk_bf16_f32 v165, v58, v62
    v_mfma_f32_16x16x16_bf16 v[84:87], v[162:163], v[186:187], v[84:87]
    v_cvt_f32_i32 v51, v51
    v_cvt_f32_i32 v55, v55
    v_cvt_f32_i32 v59, v59
    v_cvt_f32_i32 v63, v63
    v_cvt_pk_bf16_f32 v166, v51, v55
    v_cvt_pk_bf16_f32 v167, v59, v63
    v_mfma_f32_16x16x16_bf16 v[88:91], v[164:165], v[186:187], v[88:91]
    s_nop 0
    v_mfma_f32_16x16x16_bf16 v[92:95], v[166:167], v[186:187], v[92:95]
    s_waitcnt vmcnt(6)
    s_cmp_gt_i32 s83, 0
    s_cbranch_scc1 L_px93
    s_waitcnt vmcnt(5)
    s_cmp_ge_i32 s83, 0
    s_cbranch_scc1 L_px93
    s_waitcnt vmcnt(4)
L_px93:
    buffer_load_dwordx4 v[40:43], v191, s[12:15], s73 offen nt
    s_mov_b32 s91, s90
    buffer_load_ubyte v8, v13, s[44:47], s95 offen nt
    v_cvt_f32_i32 v64, v64
    v_cvt_f32_i32 v68, v68
    v_cvt_f32_i32 v72, v72
    v_cvt_f32_i32 v76, v76
    v_cvt_pk_bf16_f32 v160, v64, v68
    v_cvt_pk_bf16_f32 v161, v72, v76
    v_cvt_f32_i32 v65, v65
    v_cvt_f32_i32 v69, v69
    v_cvt_f32_i32 v73, v73
    v_cvt_f32_i32 v77, v77
    v_cvt_pk_bf16_f32 v162, v65, v69
    v_cvt_pk_bf16_f32 v163, v73, v77
    v_mfma_f32_16x16x16_bf16 v[96:99], v[160:161], v[186:187], v[96:99]
    v_cvt_f32_i32 v66, v66
    v_cvt_f32_i32 v70, v70
    v_cvt_f32_i32 v74, v74
    v_cvt_f32_i32 v78, v78
    v_cvt_pk_bf16_f32 v164, v66, v70
    v_cvt_pk_bf16_f32 v165, v74, v78
    v_mfma_f32_16x16x16_bf16 v[100:103], v[162:163], v[186:187], v[100:103]
    v_cvt_f32_i32 v67, v67
    v_cvt_f32_i32 v71, v71
    v_cvt_f32_i32 v75, v75
    v_cvt_f32_i32 v79, v79
    v_cvt_pk_bf16_f32 v166, v67, v71
    v_cvt_pk_bf16_f32 v167, v75, v79
    v_mfma_f32_16x16x16_bf16 v[104:107], v[164:165], v[186:187], v[104:107]
    s_nop 0
    v_mfma_f32_16x16x16_bf16 v[108:111], v[166:167], v[186:187], v[108:111]
    s_waitcnt vmcnt(7)
    s_cmp_gt_i32 s83, 4
    s_cbranch_scc1 L_px94
    s_waitcnt vmcnt(6)
L_px94:
    buffer_load_dwordx4 v[44:47], v208, s[12:15], s73 offen nt
    s_waitcnt vmcnt(7)
    s_cmp_gt_i32 s83, 2
    s_cbranch_scc1 L_px95
    s_waitcnt vmcnt(6)
L_px95:
    s_and_b32 s80, s79, 31
    s_lshl_b32 s80, s80, 16
    s_add_u32 s72, s80, s78
    s_xor_b32 s73, s72, 4096
    s_add_u32 s79, s79, 1
    buffer_load_dwordx4 v[48:51], v1, s[12:15], s72 offen nt
    v_add_u32 v14, 1024, v14
    v_add_u32 v4, 512, v4
    v_add_u32 v15, 512, v15
    ds_read_b128 v[176:179], v14
    ds_read_b64 v[188:189], v4 offset:32768
    ds_read2_b64 a[16:19], v15 offset1:16
    ds_read2_b64 a[20:23], v15 offset0:32 offset1:48
    s_waitcnt vmcnt(7)
    s_cmp_gt_i32 s83, 6
    s_cbranch_scc1 L_px96
    s_waitcnt vmcnt(6)
L_px96:
    buffer_load_dwordx4 v[52:55], v190, s[12:15], s72 offen nt
    s_add_u32 s76, s76, 1
    s_cmp_lt_u32 s76, 14
    s_cbranch_scc1 L_vloop
    s_waitcnt vmcnt(5)
    buffer_load_dwordx4 v[56:59], v1, s[12:15], s73 offen nt
    buffer_load_dwordx4 v[60:63], v190, s[12:15], s73 offen nt
    buffer_load_dwordx4 v[64:67], v191, s[12:15], s72 offen nt
    buffer_load_dwordx4 v[68:71], v208, s[12:15], s72 offen nt
    buffer_load_dwordx4 v[72:75], v191, s[12:15], s73 offen nt
    s_waitcnt lgkmcnt(0)
    v_fma_f32 v176, v176, s77, -v5
    v_fma_f32 v177, v177, s77, -v5
    v_fma_f32 v178, v178, s77, -v5
    v_fma_f32 v179, v179, s77, -v5
    v_exp_f32 v176, v176
    v_exp_f32 v177, v177
    v_exp_f32 v178, v178
    v_exp_f32 v179, v179
    v_lshlrev_b32 v180, 16, v188
    v_and_b32 v181, s82, v188
    v_lshlrev_b32 v182, 16, v189
    v_and_b32 v183, s82, v189
    v_mul_f32 v180, v180, v176
    v_mul_f32 v181, v181, v177
    v_mul_f32 v182, v182, v178
    v_mul_f32 v183, v183, v179
    v_cvt_pk_bf16_f32 v184, v180, v181
    v_cvt_pk_bf16_f32 v185, v182, v183
    v_add_f32 v6, v6, v176
    v_add_f32 v6, v6, v177
    v_add_f32 v6, v6, v178
    v_add_f32 v6, v6, v179
    s_waitcnt vmcnt(9)
    buffer_load_dwordx4 v[76:79], v208, s[12:15], s73 offen nt
    v_mov_b32_dpp v186, v184 quad_perm:[0,1,2,3] row_mask:0xf bank_mask:0x1
    v_mov_b32_dpp v187, v185 quad_perm:[0,1,2,3] row_mask:0xf bank_mask:0x1
    v_cvt_f32_i32 v16, v16
    v_cvt_f32_i32 v20, v20
    v_cvt_f32_i32 v24, v24
    v_cvt_f32_i32 v28, v28
    v_cvt_pk_bf16_f32 v160, v16, v20
    v_cvt_pk_bf16_f32 v161, v24, v28
    v_mfma_f32_16x16x16_bf16 v[112:115], a[16:17], v[186:187], v[112:115]
    v_cvt_f32_i32 v17, v17
    v_cvt_f32_i32 v21, v21
    v_cvt_f32_i32 v25, v25
    v_cvt_f32_i32 v29, v29
    v_cvt_pk_bf16_f32 v162, v17, v21
    v_cvt_pk_bf16_f32 v163, v25, v29
    v_mfma_f32_16x16x16_bf16 v[80:83], v[160:161], v[186:187], v[80:83]
    v_cvt_f32_i32 v18, v18
    v_cvt_f32_i32 v22, v22
    v_cvt_f32_i32 v26, v26
    v_cvt_f32_i32 v30, v30
    v_cvt_pk_bf16_f32 v164, v18, v22
    v_cvt_pk_bf16_f32 v165, v26, v30
    v_mfma_f32_16x16x16_bf16 v[84:87], v[162:163], v[186:187], v[84:87]
    v_cvt_f32_i32 v19, v19
    v_cvt_f32_i32 v23, v23
    v_cvt_f32_i32 v27, v27
    v_cvt_f32_i32 v31, v31
    v_cvt_pk_bf16_f32 v166, v19, v23
    v_cvt_pk_bf16_f32 v167, v27, v31
    v_mfma_f32_16x16x16_bf16 v[88:91], v[164:165], v[186:187], v[88:91]
    s_nop 0
    v_mfma_f32_16x16x16_bf16 v[92:95], v[166:167], v[186:187], v[92:95]
    s_waitcnt vmcnt(9)
    s_and_b32 s80, s79, 31
    s_lshl_b32 s80, s80, 16
    s_add_u32 s72, s80, s78
    s_xor_b32 s73, s72, 4096
    s_add_u32 s79, s79, 1
    buffer_load_dwordx4 v[16:19], v1, s[12:15], s72 offen nt
    s_waitcnt vmcnt(9)
    buffer_load_dwordx4 v[20:23], v190, s[12:15], s72 offen nt
    v_cvt_f32_i32 v32, v32
    v_cvt_f32_i32 v36, v36
    v_cvt_f32_i32 v40, v40
    v_cvt_f32_i32 v44, v44
    v_cvt_pk_bf16_f32 v160, v32, v36
    v_cvt_pk_bf16_f32 v161, v40, v44
    v_cvt_f32_i32 v33, v33
    v_cvt_f32_i32 v37, v37
    v_cvt_f32_i32 v41, v41
    v_cvt_f32_i32 v45, v45
    v_cvt_pk_bf16_f32 v162, v33, v37
    v_cvt_pk_bf16_f32 v163, v41, v45
    v_mfma_f32_16x16x16_bf16 v[96:99], v[160:161], v[186:187], v[96:99]
    v_cvt_f32_i32 v34, v34
    v_cvt_f32_i32 v38, v38
    v_cvt_f32_i32 v42, v42
    v_cvt_f32_i32 v46, v46
    v_cvt_pk_bf16_f32 v164, v34, v38
    v_cvt_pk_bf16_f32 v165, v42, v46
    v_mfma_f32_16x16x16_bf16 v[100:103], v[162:163], v[186:187], v[100:103]
    v_cvt_f32_i32 v35, v35
    v_cvt_f32_i32 v39, v39
    v_cvt_f32_i32 v43, v43
    v_cvt_f32_i32 v47, v47
    v_cvt_pk_bf16_f32 v166, v35, v39
    v_cvt_pk_bf16_f32 v167, v43, v47
    v_mfma_f32_16x16x16_bf16 v[104:107], v[164:165], v[186:187], v[104:107]
    s_nop 0
    v_mfma_f32_16x16x16_bf16 v[108:111], v[166:167], v[186:187], v[108:111]
    s_waitcnt vmcnt(9)
    buffer_load_dwordx4 v[24:27], v1, s[12:15], s73 offen nt
    v_mov_b32 v10, v6
    v_and_b32 v9, 3, v0
    v_lshrrev_b32 v11, 4, v0
    v_permlane32_swap_b32 v6, v10
    v_add_f32 v6, v6, v10
    v_mov_b32 v10, v6
    v_lshlrev_b32 v192, 4, v9
    v_lshl_add_u32 v192, v11, 6, v192
    v_permlane16_swap_b32 v6, v10
    v_add_f32 v6, v6, v10
    v_add_u32 v192, s71, v192
    s_lshl_b32 s80, s3, 5
    v_add_f32_dpp v6, v6, v6 row_ror:4 row_mask:0xf bank_mask:0xf
    v_lshl_add_u32 v193, v9, 3, s80
    v_readlane_b32 s81, v5, s3
    v_add_f32_dpp v6, v6, v6 row_ror:8 row_mask:0xf bank_mask:0xf
    s_waitcnt vmcnt(9)
    buffer_load_dwordx4 v[28:31], v190, s[12:15], s73 offen nt
    v_and_b32 v194, 1, v0
    v_lshlrev_b32 v194, 9, v194
    v_mov_b32 v202, s81
    v_min_u32 v202, -2, v202
    v_bfe_u32 v9, v0, 1, 2
    v_lshl_add_u32 v194, v9, 2, v194
    v_bfe_u32 v9, v0, 3, 2
    v_lshl_add_u32 v194, v9, 6, v194
    v_lshrrev_b32 v9, 5, v0
    s_and_b32 s80, s69, 1
    v_xor_b32 v9, s80, v9
    v_lshl_add_u32 v194, v9, 10, v194
    s_lshl_b32 s80, s3, 4
    s_add_u32 s80, s80, 41472
    v_add_u32 v194, s80, v194
    s_lshl_b32 s80, s3, 3
    v_mov_b32 v195, s80
    v_mov_b32 v206, 0
    s_waitcnt vmcnt(9)
    buffer_load_dwordx4 v[32:35], v191, s[12:15], s72 offen nt
    v_and_b32 v196, 15, v0
    v_add_u32 v196, s69, v196
    v_and_b32 v196, 15, v196
    v_lshlrev_b32 v196, 5, v196
    v_lshlrev_b32 v197, 3, v0
    v_lshlrev_b32 v199, 2, v0
    s_lshl_b32 s16, s68, 9
    s_lshl_b32 s81, s3, 3
    s_add_u32 s16, s16, s81
    s_add_u32 s16, s16, 0x80000
    s_lshl_b32 s88, s68, 15
    s_lshl_b32 s81, s3, 9
    s_add_u32 s88, s88, s81
    s_mov_b32 s85, 0
    s_waitcnt vmcnt(9)
    buffer_load_dwordx4 v[36:39], v208, s[12:15], s72 offen nt
    v_mov_b32_dpp v186, v184 row_shl:4 row_mask:0xf bank_mask:0x1
    v_mov_b32_dpp v187, v185 row_shl:4 row_mask:0xf bank_mask:0x1
    v_cvt_f32_i32 v48, v48
    v_cvt_f32_i32 v52, v52
    v_cvt_f32_i32 v56, v56
    v_cvt_f32_i32 v60, v60
    v_cvt_pk_bf16_f32 v160, v48, v52
    v_cvt_pk_bf16_f32 v161, v56, v60
    v_mfma_f32_16x16x16_bf16 v[112:115], a[18:19], v[186:187], v[112:115]
    v_cvt_f32_i32 v49, v49
    v_cvt_f32_i32 v53, v53
    v_cvt_f32_i32 v57, v57
    v_cvt_f32_i32 v61, v61
    v_cvt_pk_bf16_f32 v162, v49, v53
    v_cvt_pk_bf16_f32 v163, v57, v61
    v_mfma_f32_16x16x16_bf16 v[80:83], v[160:161], v[186:187], v[80:83]
    v_cvt_f32_i32 v50, v50
    v_cvt_f32_i32 v54, v54
    v_cvt_f32_i32 v58, v58
    v_cvt_f32_i32 v62, v62
    v_cvt_pk_bf16_f32 v164, v50, v54
    v_cvt_pk_bf16_f32 v165, v58, v62
    v_mfma_f32_16x16x16_bf16 v[84:87], v[162:163], v[186:187], v[84:87]
    v_cvt_f32_i32 v51, v51
    v_cvt_f32_i32 v55, v55
    v_cvt_f32_i32 v59, v59
    v_cvt_f32_i32 v63, v63
    v_cvt_pk_bf16_f32 v166, v51, v55
    v_cvt_pk_bf16_f32 v167, v59, v63
    v_mfma_f32_16x16x16_bf16 v[88:91], v[164:165], v[186:187], v[88:91]
    s_nop 0
    v_mfma_f32_16x16x16_bf16 v[92:95], v[166:167], v[186:187], v[92:95]
    s_waitcnt vmcnt(9)
    buffer_load_dwordx4 v[40:43], v191, s[12:15], s73 offen nt
    s_add_u32 s81, s69, 1
    s_and_b32 s81, s81, 15
    s_lshl_b32 s81, s81, 11
    s_add_u32 s17, s81, s88
    s_add_u32 s81, s69, 2
    s_and_b32 s81, s81, 15
    s_lshl_b32 s81, s81, 11
    s_add_u32 s18, s81, s88
    s_add_u32 s81, s69, 3
    s_and_b32 s81, s81, 15
    s_lshl_b32 s81, s81, 11
    s_add_u32 s19, s81, s88
    s_waitcnt vmcnt(9)
    buffer_load_dwordx4 v[44:47], v208, s[12:15], s73 offen nt
    s_add_u32 s81, s69, 4
    s_and_b32 s81, s81, 15
    s_lshl_b32 s81, s81, 11
    s_add_u32 s20, s81, s88
    s_add_u32 s81, s69, 5
    s_and_b32 s81, s81, 15
    s_lshl_b32 s81, s81, 11
    s_add_u32 s21, s81, s88
    s_add_u32 s81, s69, 6
    s_and_b32 s81, s81, 15
    s_lshl_b32 s81, s81, 11
    s_add_u32 s22, s81, s88
    s_add_u32 s81, s69, 7
    s_and_b32 s81, s81, 15
    s_lshl_b32 s81, s81, 11
    s_add_u32 s23, s81, s88
    s_waitcnt vmcnt(9)
    s_and_b32 s80, s79, 31
    s_lshl_b32 s80, s80, 16
    s_add_u32 s72, s80, s78
    s_xor_b32 s73, s72, 4096
    s_add_u32 s79, s79, 1
    buffer_load_dwordx4 v[48:51], v1, s[12:15], s72 offen nt
    s_add_u32 s81, s69, 8
    s_and_b32 s81, s81, 15
    s_lshl_b32 s81, s81, 11
    s_add_u32 s24, s81, s88
    s_add_u32 s81, s69, 9
    s_and_b32 s81, s81, 15
    s_lshl_b32 s81, s81, 11
    s_add_u32 s25, s81, s88
    s_add_u32 s81, s69, 10
    s_and_b32 s81, s81, 15
    s_lshl_b32 s81, s81, 11
    s_add_u32 s26, s81, s88
    s_add_u32 s81, s69, 11
    s_and_b32 s81, s81, 15
    s_lshl_b32 s81, s81, 11
    s_add_u32 s27, s81, s88
    s_waitcnt vmcnt(9)
    buffer_load_dwordx4 v[52:55], v190, s[12:15], s72 offen nt
    v_cvt_f32_i32 v64, v64
    v_cvt_f32_i32 v68, v68
    v_cvt_f32_i32 v72, v72
    v_cvt_f32_i32 v76, v76
    v_cvt_pk_bf16_f32 v160, v64, v68
    v_cvt_pk_bf16_f32 v161, v72, v76
    v_cvt_f32_i32 v65, v65
    v_cvt_f32_i32 v69, v69
    v_cvt_f32_i32 v73, v73
    v_cvt_f32_i32 v77, v77
    v_cvt_pk_bf16_f32 v162, v65, v69
    v_cvt_pk_bf16_f32 v163, v73, v77
    v_mfma_f32_16x16x16_bf16 v[96:99], v[160:161], v[186:187], v[96:99]
    v_cvt_f32_i32 v66, v66
    v_cvt_f32_i32 v70, v70
    v_cvt_f32_i32 v74, v74
    v_cvt_f32_i32 v78, v78
    v_cvt_pk_bf16_f32 v164, v66, v70
    v_cvt_pk_bf16_f32 v165, v74, v78
    v_mfma_f32_16x16x16_bf16 v[100:103], v[162:163], v[186:187], v[100:103]
    v_cvt_f32_i32 v67, v67
    v_cvt_f32_i32 v71, v71
    v_cvt_f32_i32 v75, v75
    v_cvt_f32_i32 v79, v79
    v_cvt_pk_bf16_f32 v166, v67, v71
    v_cvt_pk_bf16_f32 v167, v75, v79
    v_mfma_f32_16x16x16_bf16 v[104:107], v[164:165], v[186:187], v[104:107]
    s_nop 0
    v_mfma_f32_16x16x16_bf16 v[108:111], v[166:167], v[186:187], v[108:111]
    s_add_u32 s81, s69, 12
    s_and_b32 s81, s81, 15
    s_lshl_b32 s81, s81, 11
    s_add_u32 s28, s81, s88
    s_add_u32 s81, s69, 13
    s_and_b32 s81, s81, 15
    s_lshl_b32 s81, s81, 11
    s_add_u32 s29, s81, s88
    s_add_u32 s81, s69, 14
    s_and_b32 s81, s81, 15
    s_lshl_b32 s81, s81, 11
    s_add_u32 s30, s81, s88
    s_add_u32 s81, s69, 15
    s_and_b32 s81, s81, 15
    s_lshl_b32 s81, s81, 11
    s_add_u32 s31, s81, s88
    s_waitcnt vmcnt(9)
    buffer_load_dwordx4 v[56:59], v1, s[12:15], s73 offen nt
    s_mov_b32 s88, 0x00010001
    s_mov_b32 s89, 0x00010001
    s_lshl_b32 s70, s68, 10
    s_lshl_b32 s81, s3, 8
    s_add_u32 s70, s70, s81
    s_waitcnt vmcnt(9)
    buffer_load_dwordx4 v[60:63], v190, s[12:15], s73 offen nt
    s_waitcnt vmcnt(9)
    buffer_load_dwordx4 v[64:67], v191, s[12:15], s72 offen nt
    s_waitcnt vmcnt(9)
    buffer_load_dwordx4 v[68:71], v208, s[12:15], s72 offen nt
    v_mov_b32_dpp v186, v184 row_shl:8 row_mask:0xf bank_mask:0x1
    v_mov_b32_dpp v187, v185 row_shl:8 row_mask:0xf bank_mask:0x1
    v_cvt_f32_i32 v16, v16
    v_cvt_f32_i32 v20, v20
    v_cvt_f32_i32 v24, v24
    v_cvt_f32_i32 v28, v28
    v_cvt_pk_bf16_f32 v160, v16, v20
    v_cvt_pk_bf16_f32 v161, v24, v28
    v_mfma_f32_16x16x16_bf16 v[112:115], a[20:21], v[186:187], v[112:115]
    v_cvt_f32_i32 v17, v17
    v_cvt_f32_i32 v21, v21
    v_cvt_f32_i32 v25, v25
    v_cvt_f32_i32 v29, v29
    v_cvt_pk_bf16_f32 v162, v17, v21
    v_cvt_pk_bf16_f32 v163, v25, v29
    v_mfma_f32_16x16x16_bf16 v[80:83], v[160:161], v[186:187], v[80:83]
    v_cvt_f32_i32 v18, v18
    v_cvt_f32_i32 v22, v22
    v_cvt_f32_i32 v26, v26
    v_cvt_f32_i32 v30, v30
    v_cvt_pk_bf16_f32 v164, v18, v22
    v_cvt_pk_bf16_f32 v165, v26, v30
    v_mfma_f32_16x16x16_bf16 v[84:87], v[162:163], v[186:187], v[84:87]
    v_cvt_f32_i32 v19, v19
    v_cvt_f32_i32 v23, v23
    v_cvt_f32_i32 v27, v27
    v_cvt_f32_i32 v31, v31
    v_cvt_pk_bf16_f32 v166, v19, v23
    v_cvt_pk_bf16_f32 v167, v27, v31
    v_mfma_f32_16x16x16_bf16 v[88:91], v[164:165], v[186:187], v[88:91]
    s_nop 0
    v_mfma_f32_16x16x16_bf16 v[92:95], v[166:167], v[186:187], v[92:95]
    s_waitcnt vmcnt(9)
    buffer_load_dwordx4 v[72:75], v191, s[12:15], s73 offen nt
    s_waitcnt vmcnt(9)
    buffer_load_dwordx4 v[76:79], v208, s[12:15], s73 offen nt
    s_waitcnt vmcnt(8)
    v_cvt_f32_i32 v32, v32
    v_cvt_f32_i32 v36, v36
    v_cvt_f32_i32 v40, v40
    v_cvt_f32_i32 v44, v44
    v_cvt_pk_bf16_f32 v160, v32, v36
    v_cvt_pk_bf16_f32 v161, v40, v44
    v_cvt_f32_i32 v33, v33
    v_cvt_f32_i32 v37, v37
    v_cvt_f32_i32 v41, v41
    v_cvt_f32_i32 v45, v45
    v_cvt_pk_bf16_f32 v162, v33, v37
    v_cvt_pk_bf16_f32 v163, v41, v45
    v_mfma_f32_16x16x16_bf16 v[96:99], v[160:161], v[186:187], v[96:99]
    v_cvt_f32_i32 v34, v34
    v_cvt_f32_i32 v38, v38
    v_cvt_f32_i32 v42, v42
    v_cvt_f32_i32 v46, v46
    v_cvt_pk_bf16_f32 v164, v34, v38
    v_cvt_pk_bf16_f32 v165, v42, v46
    v_mfma_f32_16x16x16_bf16 v[100:103], v[162:163], v[186:187], v[100:103]
    v_cvt_f32_i32 v35, v35
    v_cvt_f32_i32 v39, v39
    v_cvt_f32_i32 v43, v43
    v_cvt_f32_i32 v47, v47
    v_cvt_pk_bf16_f32 v166, v35, v39
    v_cvt_pk_bf16_f32 v167, v43, v47
    v_mfma_f32_16x16x16_bf16 v[104:107], v[164:165], v[186:187], v[104:107]
    s_nop 0
    v_mfma_f32_16x16x16_bf16 v[108:111], v[166:167], v[186:187], v[108:111]
    s_waitcnt vmcnt(4)
    s_cmp_lg_u32 s3, 0
    s_cbranch_scc1 L_notk
    s_mov_b32 s84, 1
    s_atomic_add s84, s[66:67], 0 glc
L_notk:
    v_mov_b32_dpp v186, v184 row_shl:12 row_mask:0xf bank_mask:0x1
    v_mov_b32_dpp v187, v185 row_shl:12 row_mask:0xf bank_mask:0x1
    v_cvt_f32_i32 v48, v48
    v_cvt_f32_i32 v52, v52
    v_cvt_f32_i32 v56, v56
    v_cvt_f32_i32 v60, v60
    v_cvt_pk_bf16_f32 v160, v48, v52
    v_cvt_pk_bf16_f32 v161, v56, v60
    v_mfma_f32_16x16x16_bf16 v[112:115], a[22:23], v[186:187], v[112:115]
    v_cvt_f32_i32 v49, v49
    v_cvt_f32_i32 v53, v53
    v_cvt_f32_i32 v57, v57
    v_cvt_f32_i32 v61, v61
    v_cvt_pk_bf16_f32 v162, v49, v53
    v_cvt_pk_bf16_f32 v163, v57, v61
    v_mfma_f32_16x16x16_bf16 v[80:83], v[160:161], v[186:187], v[80:83]
    v_cvt_f32_i32 v50, v50
    v_cvt_f32_i32 v54, v54
    v_cvt_f32_i32 v58, v58
    v_cvt_f32_i32 v62, v62
    v_cvt_pk_bf16_f32 v164, v50, v54
    v_cvt_pk_bf16_f32 v165, v58, v62
    v_mfma_f32_16x16x16_bf16 v[84:87], v[162:163], v[186:187], v[84:87]
    v_cvt_f32_i32 v51, v51
    v_cvt_f32_i32 v55, v55
    v_cvt_f32_i32 v59, v59
    v_cvt_f32_i32 v63, v63
    v_cvt_pk_bf16_f32 v166, v51, v55
    v_cvt_pk_bf16_f32 v167, v59, v63
    v_mfma_f32_16x16x16_bf16 v[88:91], v[164:165], v[186:187], v[88:91]
    s_nop 0
    v_mfma_f32_16x16x16_bf16 v[92:95], v[166:167], v[186:187], v[92:95]
    s_nop 5
    s_mov_b32 exec_lo, 0x000f000f
    s_mov_b32 exec_hi, 0x000f000f
    v_mov_b32 v7, v112
    ds_write_b128 v192, v[80:83] offset:0
    ds_write_b128 v192, v[84:87] offset:256
    ds_write_b128 v192, v[88:91] offset:512
    ds_write_b128 v192, v[92:95] offset:768
    s_mov_b64 exec, 15
    ds_write_b64 v193, v[6:7] offset:40960
    s_mov_b64 exec, -1
    s_waitcnt vmcnt(0)
    v_cvt_f32_i32 v64, v64
    v_cvt_f32_i32 v68, v68
    v_cvt_f32_i32 v72, v72
    v_cvt_f32_i32 v76, v76
    v_cvt_pk_bf16_f32 v160, v64, v68
    v_cvt_pk_bf16_f32 v161, v72, v76
    v_cvt_f32_i32 v65, v65
    v_cvt_f32_i32 v69, v69
    v_cvt_f32_i32 v73, v73
    v_cvt_f32_i32 v77, v77
    v_cvt_pk_bf16_f32 v162, v65, v69
    v_cvt_pk_bf16_f32 v163, v73, v77
    v_mfma_f32_16x16x16_bf16 v[96:99], v[160:161], v[186:187], v[96:99]
    v_cvt_f32_i32 v66, v66
    v_cvt_f32_i32 v70, v70
    v_cvt_f32_i32 v74, v74
    v_cvt_f32_i32 v78, v78
    v_cvt_pk_bf16_f32 v164, v66, v70
    v_cvt_pk_bf16_f32 v165, v74, v78
    v_mfma_f32_16x16x16_bf16 v[100:103], v[162:163], v[186:187], v[100:103]
    v_cvt_f32_i32 v67, v67
    v_cvt_f32_i32 v71, v71
    v_cvt_f32_i32 v75, v75
    v_cvt_f32_i32 v79, v79
    v_cvt_pk_bf16_f32 v166, v67, v71
    v_cvt_pk_bf16_f32 v167, v75, v79
    v_mfma_f32_16x16x16_bf16 v[104:107], v[164:165], v[186:187], v[104:107]
    s_nop 0
    v_mfma_f32_16x16x16_bf16 v[108:111], v[166:167], v[186:187], v[108:111]
    s_nop 5
    s_mov_b32 exec_lo, 0x000f000f
    s_mov_b32 exec_hi, 0x000f000f
    ds_write_b128 v192, v[96:99] offset:1024
    ds_write_b128 v192, v[100:103] offset:1280
    ds_write_b128 v192, v[104:107] offset:1536
    ds_write_b128 v192, v[108:111] offset:1792
    s_mov_b64 exec, -1
L_tail:
    s_cmp_lg_u32 s3, 0
    s_cbranch_scc1 L_nofl
    s_waitcnt lgkmcnt(0)
    v_mov_b32 v198, s84
    ds_write_b32 v206, v198 offset:41152
L_nofl:
    s_waitcnt lgkmcnt(0)
    s_barrier
    ds_read_b32 v198, v206 offset:41152
    ds_read2st64_b32 v[16:17], v194 offset0:0 offset1:1
    ds_read2st64_b32 v[18:19], v194 offset0:64 offset1:65
    ds_read2st64_b32 v[20:21], v194 offset0:128 offset1:129
    ds_read2st64_b32 v[22:23], v194 offset0:192 offset1:193
    ds_read_b64 v[24:25], v195 offset:40960
    ds_read_b64 v[26:27], v195 offset:40992
    ds_read_b64 v[28:29], v195 offset:41024
    ds_read_b64 v[30:31], v195 offset:41056
    s_waitcnt lgkmcnt(8)
    v_readfirstlane_b32 s84, v198
    s_cmp_lg_u32 s84, 15
    s_cbranch_scc1 L_nold
    buffer_load_dwordx2 v[204:205], v196, s[40:43], s16 offen sc1
    buffer_load_dwordx2 v[130:131], v197, s[40:43], s17 offen sc1
    buffer_load_dwordx2 v[132:133], v197, s[40:43], s18 offen sc1
    buffer_load_dwordx2 v[134:135], v197, s[40:43], s19 offen sc1
    buffer_load_dwordx2 v[136:137], v197, s[40:43], s20 offen sc1
    buffer_load_dwordx2 v[138:139], v197, s[40:43], s21 offen sc1
    buffer_load_dwordx2 v[140:141], v197, s[40:43], s22 offen sc1
    buffer_load_dwordx2 v[142:143], v197, s[40:43], s23 offen sc1
    buffer_load_dwordx2 v[144:145], v197, s[40:43], s24 offen sc1
    buffer_load_dwordx2 v[146:147], v197, s[40:43], s25 offen sc1
    buffer_load_dwordx2 v[148:149], v197, s[40:43], s26 offen sc1
    buffer_load_dwordx2 v[150:151], v197, s[40:43], s27 offen sc1
    buffer_load_dwordx2 v[152:153], v197, s[40:43], s28 offen sc1
    buffer_load_dwordx2 v[154:155], v197, s[40:43], s29 offen sc1
    buffer_load_dwordx2 v[156:157], v197, s[40:43], s30 offen sc1
    buffer_load_dwordx2 v[158:159], v197, s[40:43], s31 offen sc1
L_nold:
    s_waitcnt lgkmcnt(4)
    v_add_f32 v16, v16, v18
    v_add_f32 v17, v17, v19
    v_add_f32 v20, v20, v22
    v_add_f32 v21, v21, v23
    s_waitcnt lgkmcnt(0)
    v_add_f32 v24, v24, v26
    v_add_f32 v25, v25, v27
    v_add_f32 v28, v28, v30
    v_add_f32 v29, v29, v31
    v_add_f32 v16, v16, v20
    v_add_f32 v17, v17, v21
    v_add_f32 v25, v25, v29
    v_add_f32 v203, v24, v28
    v_sub_f32 v200, v16, v25
    v_sub_f32 v201, v17, v25
    v_min_u32 v203, -2, v203
    v_min_u32 v200, -2, v200
    v_min_u32 v201, -2, v201
    s_cmp_eq_u32 s84, 15
    s_cbranch_scc1 L_last
    buffer_store_dwordx2 v[200:201], v197, s[40:43], s74 offen sc1
    s_mov_b64 exec, 1
    buffer_store_dwordx2 v[202:203], v197, s[40:43], s75 offen sc1
    s_mov_b64 exec, -1
    s_branch L_end
L_again:
    buffer_load_dwordx2 v[204:205], v196, s[40:43], s16 offen sc1
    buffer_load_dwordx2 v[130:131], v197, s[40:43], s17 offen sc1
    buffer_load_dwordx2 v[132:133], v197, s[40:43], s18 offen sc1
    buffer_load_dwordx2 v[134:135], v197, s[40:43], s19 offen sc1
    buffer_load_dwordx2 v[136:137], v197, s[40:43], s20 offen sc1
    buffer_load_dwordx2 v[138:139], v197, s[40:43], s21 offen sc1
    buffer_load_dwordx2 v[140:141], v197, s[40:43], s22 offen sc1
    buffer_load_dwordx2 v[142:143], v197, s[40:43], s23 offen sc1
    buffer_load_dwordx2 v[144:145], v197, s[40:43], s24 offen sc1
    buffer_load_dwordx2 v[146:147], v197, s[40:43], s25 offen sc1
    buffer_load_dwordx2 v[148:149], v197, s[40:43], s26 offen sc1
    buffer_load_dwordx2 v[150:151], v197, s[40:43], s27 offen sc1
    buffer_load_dwordx2 v[152:153], v197, s[40:43], s28 offen sc1
    buffer_load_dwordx2 v[154:155], v197, s[40:43], s29 offen sc1
    buffer_load_dwordx2 v[156:157], v197, s[40:43], s30 offen sc1
    buffer_load_dwordx2 v[158:159], v197, s[40:43], s31 offen sc1
L_last:
    s_waitcnt vmcnt(15)
    v_cndmask_b32 v204, v204, v202, s[88:89]
    v_cndmask_b32 v205, v205, v203, s[88:89]
    v_max_u32 v16, v204, v205
    v_mov_b32 v17, v204
    s_nop 1
    v_max_f32_dpp v17, v17, v17 row_ror:8 row_mask:0xf bank_mask:0xf
    s_nop 1
    v_max_f32_dpp v17, v17, v17 row_ror:4 row_mask:0xf bank_mask:0xf
    s_nop 1
    v_max_f32_dpp v17, v17, v17 row_ror:2 row_mask:0xf bank_mask:0xf
    s_nop 1
    v_max_f32_dpp v17, v17, v17 row_ror:1 row_mask:0xf bank_mask:0xf
    v_sub_f32 v17, v204, v17
    v_exp_f32 v17, v17
    s_nop 0
    v_mul_f32 v18, v205, v17
    s_nop 1
    v_add_f32_dpp v18, v18, v18 row_ror:8 row_mask:0xf bank_mask:0xf
    s_nop 1
    v_add_f32_dpp v18, v18, v18 row_ror:4 row_mask:0xf bank_mask:0xf
    s_nop 1
    v_add_f32_dpp v18, v18, v18 row_ror:2 row_mask:0xf bank_mask:0xf
    s_nop 1
    v_add_f32_dpp v18, v18, v18 row_ror:1 row_mask:0xf bank_mask:0xf
    v_rcp_f32 v18, v18
    s_add_u32 s85, s85, 1
    v_mul_f32 v17, v17, v18
    s_nop 1
    v_mul_f32_dpp v20, v17, v200 row_newbcast:0 row_mask:0xf bank_mask:0xf
    v_mul_f32_dpp v21, v17, v201 row_newbcast:0 row_mask:0xf bank_mask:0xf
    s_waitcnt vmcnt(14)
    v_max3_u32 v16, v16, v130, v131
    v_fmac_f32_dpp v20, v17, v130 row_newbcast:1 row_mask:0xf bank_mask:0xf
    v_fmac_f32_dpp v21, v17, v131 row_newbcast:1 row_mask:0xf bank_mask:0xf
    s_waitcnt vmcnt(13)
    v_max3_u32 v16, v16, v132, v133
    v_fmac_f32_dpp v20, v17, v132 row_newbcast:2 row_mask:0xf bank_mask:0xf
    v_fmac_f32_dpp v21, v17, v133 row_newbcast:2 row_mask:0xf bank_mask:0xf
    s_waitcnt vmcnt(12)
    v_max3_u32 v16, v16, v134, v135
    v_fmac_f32_dpp v20, v17, v134 row_newbcast:3 row_mask:0xf bank_mask:0xf
    v_fmac_f32_dpp v21, v17, v135 row_newbcast:3 row_mask:0xf bank_mask:0xf
    s_waitcnt vmcnt(11)
    v_max3_u32 v16, v16, v136, v137
    v_fmac_f32_dpp v20, v17, v136 row_newbcast:4 row_mask:0xf bank_mask:0xf
    v_fmac_f32_dpp v21, v17, v137 row_newbcast:4 row_mask:0xf bank_mask:0xf
    s_waitcnt vmcnt(10)
    v_max3_u32 v16, v16, v138, v139
    v_fmac_f32_dpp v20, v17, v138 row_newbcast:5 row_mask:0xf bank_mask:0xf
    v_fmac_f32_dpp v21, v17, v139 row_newbcast:5 row_mask:0xf bank_mask:0xf
    s_waitcnt vmcnt(9)
    v_max3_u32 v16, v16, v140, v141
    v_fmac_f32_dpp v20, v17, v140 row_newbcast:6 row_mask:0xf bank_mask:0xf
    v_fmac_f32_dpp v21, v17, v141 row_newbcast:6 row_mask:0xf bank_mask:0xf
    s_waitcnt vmcnt(8)
    v_max3_u32 v16, v16, v142, v143
    v_fmac_f32_dpp v20, v17, v142 row_newbcast:7 row_mask:0xf bank_mask:0xf
    v_fmac_f32_dpp v21, v17, v143 row_newbcast:7 row_mask:0xf bank_mask:0xf
    s_waitcnt vmcnt(7)
    v_max3_u32 v16, v16, v144, v145
    v_fmac_f32_dpp v20, v17, v144 row_newbcast:8 row_mask:0xf bank_mask:0xf
    v_fmac_f32_dpp v21, v17, v145 row_newbcast:8 row_mask:0xf bank_mask:0xf
    s_waitcnt vmcnt(6)
    v_max3_u32 v16, v16, v146, v147
    v_fmac_f32_dpp v20, v17, v146 row_newbcast:9 row_mask:0xf bank_mask:0xf
    v_fmac_f32_dpp v21, v17, v147 row_newbcast:9 row_mask:0xf bank_mask:0xf
    s_waitcnt vmcnt(5)
    v_max3_u32 v16, v16, v148, v149
    v_fmac_f32_dpp v20, v17, v148 row_newbcast:10 row_mask:0xf bank_mask:0xf
    v_fmac_f32_dpp v21, v17, v149 row_newbcast:10 row_mask:0xf bank_mask:0xf
    s_waitcnt vmcnt(4)
    v_max3_u32 v16, v16, v150, v151
    v_fmac_f32_dpp v20, v17, v150 row_newbcast:11 row_mask:0xf bank_mask:0xf
    v_fmac_f32_dpp v21, v17, v151 row_newbcast:11 row_mask:0xf bank_mask:0xf
    s_waitcnt vmcnt(3)
    v_max3_u32 v16, v16, v152, v153
    v_fmac_f32_dpp v20, v17, v152 row_newbcast:12 row_mask:0xf bank_mask:0xf
    v_fmac_f32_dpp v21, v17, v153 row_newbcast:12 row_mask:0xf bank_mask:0xf
    s_waitcnt vmcnt(2)
    v_max3_u32 v16, v16, v154, v155
    v_fmac_f32_dpp v20, v17, v154 row_newbcast:13 row_mask:0xf bank_mask:0xf
    v_fmac_f32_dpp v21, v17, v155 row_newbcast:13 row_mask:0xf bank_mask:0xf
    s_waitcnt vmcnt(1)
    v_max3_u32 v16, v16, v156, v157
    v_fmac_f32_dpp v20, v17, v156 row_newbcast:14 row_mask:0xf bank_mask:0xf
    v_fmac_f32_dpp v21, v17, v157 row_newbcast:14 row_mask:0xf bank_mask:0xf
    s_waitcnt vmcnt(0)
    v_max3_u32 v16, v16, v158, v159
    v_fmac_f32_dpp v20, v17, v158 row_newbcast:15 row_mask:0xf bank_mask:0xf
    v_fmac_f32_dpp v21, v17, v159 row_newbcast:15 row_mask:0xf bank_mask:0xf
    v_cmp_eq_u32 vcc, -1, v16
    v_cvt_pk_bf16_f32 v20, v20, v21
    s_cmp_ge_u32 s85, 0x100000
    s_cbranch_scc1 L_ok
    s_cbranch_vccnz L_again
L_ok:
    buffer_store_dword v20, v199, s[36:39], s70 offen
L_end:
L_exit:
    s_endpgm
.section .rodata,"a"
.p2align 6
.amdhsa_kernel standalone__kv_cache_quant_int4_int2_kv_with_per_channel_or_per_token_scales__decode_kernel
  .amdhsa_next_free_vgpr 236
  .amdhsa_next_free_sgpr 100
  .amdhsa_accum_offset 212
  .amdhsa_group_segment_fixed_size 0
  .amdhsa_kernarg_size 80
  .amdhsa_user_sgpr_count 2
  .amdhsa_user_sgpr_kernarg_segment_ptr 1
  .amdhsa_system_sgpr_workgroup_id_x 1
.end_amdhsa_kernel
```
